```python
import torch

def _softmax(x, axis=-1):
    return torch.softmax(x, dim=axis)
def _gelu(x):
    return torch.nn.functional.gelu(x, approximate="tanh")
def _silu(x):
    return torch.nn.functional.silu(x)
def _sigmoid(x):
    return torch.sigmoid(x)
def _layernorm(x, axis=-1, eps=1e-5):
    m = x.mean(dim=axis, keepdim=True)
    v = x.var(dim=axis, keepdim=True, unbiased=False)
    return (x - m) / torch.sqrt(v + eps)
def _scatter_add(tgt, idx, src, axis=0):
    return tgt.clone().index_add_(axis, idx, src)
def _segment_sum(src, seg, n):
    out = torch.zeros((n,) + src.shape[1:], dtype=src.dtype)
    return out.index_add_(0, seg, src)
def _pad(x, pw):
    flat = tuple(v for pair in reversed(pw) for v in pair)
    return torch.nn.functional.pad(x, flat)

kernel_name = 'sequential_preLN__sliding_block_cached__dense_activation_squared_relu__decode'

def setup_inputs():

    _w = (lambda a: (lambda t: t.to(torch.bfloat16) if t.is_floating_point() else t)(torch.as_tensor(a)))
    def _A_setup():
        B, Sq, D = 1, 1, 576
        Hq, Hkv, Sk, Dh = 32, 16, 65536, 128
        assert Hq % Hkv == 0, (Hq, Hkv)
        return {
            "x": _w((lambda *s: torch.randn(*s, dtype=torch.bfloat16) * 0.05)(B, Sq, D)),
            "k_cache": _w((lambda *s: torch.randn(*s, dtype=torch.bfloat16) * 3.2)(B, Hkv, Sk, Dh)),
            "v_cache": _w((lambda *s: torch.randn(*s, dtype=torch.bfloat16) * 0.4)(B, Hkv, Sk, Dh)),
            "wq": _w((lambda *s: torch.randn(*s, dtype=torch.bfloat16) * 3.2)(D, Hq * Dh) * (D ** -0.5)),
            "wo": _w((lambda *s: torch.randn(*s, dtype=torch.bfloat16) * 0.4)(Hq * Dh, D) * ((Hq * Dh) ** -0.5)),
        }
    _A_in = _A_setup()

    def _B_setup():
        B, S, D, F = 1, 1, 576, 4608
        return {
            "x": _w((lambda *s: torch.randn(*s, dtype=torch.bfloat16) * 0.05)(B, S, D)),
            "w1": _w((lambda *s: torch.randn(*s, dtype=torch.bfloat16) * 0.05)(D, F)),
            "b1": _w((lambda *s: torch.randn(*s, dtype=torch.bfloat16) * 0.8)(F)),
            "w2": _w((lambda *s: torch.randn(*s, dtype=torch.bfloat16) * 0.05)(F, D)),
            "b2": _w((lambda *s: torch.randn(*s, dtype=torch.bfloat16) * 3.2)(D)),
        }
    _B_in = _B_setup()

    return {
        "A_x": _A_in["x"],
        "A_k_cache": _A_in["k_cache"],
        "A_v_cache": _A_in["v_cache"],
        "A_wq": _A_in["wq"],
        "A_wo": _A_in["wo"],
        "B_x": _B_in["x"],
        "B_w1": _B_in["w1"],
        "B_b1": _B_in["b1"],
        "B_w2": _B_in["w2"],
        "B_b2": _B_in["b2"],
    }

def reference(A_x, A_k_cache, A_v_cache, A_wq, A_wo, B_x, B_w1, B_b1, B_w2, B_b2):
    def _A_ref(x, k_cache, v_cache, wq, wo):
        B, Sq, D = x.shape
        Hq, Dh = 32, 128
        Hkv, Sk = k_cache.shape[1], k_cache.shape[2]
        W = min(4096, max(256, Sk // 4))
        rep = Hq // Hkv
        q = (lambda x, *d: x.permute(*d))((x @ wq).reshape(B, Sq, Hq, Dh), 0, 2, 1, 3)
        k = (lambda x, n, axis: torch.repeat_interleave(x, n, dim=axis))(k_cache[:, :, Sk - W:, :], rep, axis=1)
        v = (lambda x, n, axis: torch.repeat_interleave(x, n, dim=axis))(v_cache[:, :, Sk - W:, :], rep, axis=1)
        scores = torch.einsum("bhqd,bhkd->bhqk", q, k) * (Dh ** -0.5)
        p = _softmax(scores, axis=-1)
        o = torch.einsum("bhqk,bhkd->bhqd", p, v)
        return (lambda x, *d: x.permute(*d))(o, 0, 2, 1, 3).reshape(B, Sq, Hq * Dh) @ wo

    def _B_ref(x, w1, b1, w2, b2):
        h = torch.einsum("bsd,df->bsf", x, w1) + b1
        zero = torch.zeros_like(h)
        r = torch.where(h > zero, h, zero)
        h = r * r
        out = torch.einsum("bsf,fd->bsd", h, w2) + b2
        return out

    x = A_x
    h = x + _A_ref(_layernorm(x, axis=-1), A_k_cache, A_v_cache, A_wq, A_wo)
    h2 = h + _B_ref(_layernorm(h, axis=-1), B_w1, B_b1, B_w2, B_b2)
    return h2
```

```asm
; @launch kernel=k1_qproj_kernel grid=(128,1,1) block=(256,1,1) lds=10496
; @launch kernel=k2_attn_kernel grid=(256,1,1) block=(512,1,1) lds=33280
; @launch kernel=k3_wo_kernel grid=(256,1,1) block=(576,1,1) lds=18496
; @launch kernel=k4_mlp_kernel grid=(144,1,1) block=(576,1,1) lds=23296
.amdgcn_target "amdgcn-amd-amdhsa--gfx950"
.text
.p2align 8
.globl k1_qproj_kernel
.type k1_qproj_kernel,@function
k1_qproj_kernel:
    s_cmp_ge_u32 s2, 128
    s_cbranch_scc1 K1_END
    s_load_dwordx2 s[4:5], s[0:1], 0
    s_load_dwordx2 s[6:7], s[0:1], 24
    s_load_dwordx2 s[8:9], s[0:1], 96
    s_and_b32 s10, s2, 31
    s_lshr_b32 s11, s2, 5
    s_mul_i32 s12, s11, 144
    v_and_b32 v1, 15, v0
    v_lshrrev_b32 v2, 4, v0
    v_add_u32 v3, s12, v2
    v_lshlrev_b32 v4, 13, v3
    s_lshl_b32 s13, s10, 8
    v_lshlrev_b32 v5, 4, v1
    v_add3_u32 v4, v4, v5, s13
    v_and_b32 v6, 63, v0
    v_lshlrev_b32 v7, 1, v6
    s_waitcnt lgkmcnt(0)

    global_load_ushort v10, v7, s[4:5] offset:0
    global_load_ushort v11, v7, s[4:5] offset:128
    global_load_ushort v12, v7, s[4:5] offset:256
    global_load_ushort v13, v7, s[4:5] offset:384
    global_load_ushort v14, v7, s[4:5] offset:512
    global_load_ushort v15, v7, s[4:5] offset:640
    global_load_ushort v16, v7, s[4:5] offset:768
    global_load_ushort v17, v7, s[4:5] offset:896
    global_load_ushort v18, v7, s[4:5] offset:1024
    global_load_dwordx4 v[32:35], v4, s[6:7] nt
    v_add_u32 v4, 0x20000, v4
    global_load_dwordx4 v[36:39], v4, s[6:7] nt
    v_add_u32 v4, 0x20000, v4
    global_load_dwordx4 v[40:43], v4, s[6:7] nt
    v_add_u32 v4, 0x20000, v4
    global_load_dwordx4 v[44:47], v4, s[6:7] nt
    v_add_u32 v4, 0x20000, v4
    global_load_dwordx4 v[48:51], v4, s[6:7] nt
    v_add_u32 v4, 0x20000, v4
    global_load_dwordx4 v[52:55], v4, s[6:7] nt
    v_add_u32 v4, 0x20000, v4
    global_load_dwordx4 v[56:59], v4, s[6:7] nt
    v_add_u32 v4, 0x20000, v4
    global_load_dwordx4 v[60:63], v4, s[6:7] nt
    v_add_u32 v4, 0x20000, v4
    global_load_dwordx4 v[64:67], v4, s[6:7] nt
    s_waitcnt vmcnt(9)
    s_mul_i32 s14, s2, 576
    v_lshlrev_b32 v8, 2, v0
    v_add_u32 v8, s14, v8
    v_add_u32 v8, 331776, v8
    v_mov_b32 v9, 0
    v_cmp_gt_u32 vcc, 144, v0
    s_and_saveexec_b64 s[16:17], vcc
    global_store_dword v8, v9, s[8:9]
    v_mov_b32 v8, 405504
    global_store_dword v8, v9, s[8:9]
    s_mov_b64 exec, s[16:17]

    v_lshlrev_b32 v10, 16, v10
    v_lshlrev_b32 v11, 16, v11
    v_lshlrev_b32 v12, 16, v12
    v_lshlrev_b32 v13, 16, v13
    v_lshlrev_b32 v14, 16, v14
    v_lshlrev_b32 v15, 16, v15
    v_lshlrev_b32 v16, 16, v16
    v_lshlrev_b32 v17, 16, v17
    v_lshlrev_b32 v18, 16, v18
    v_add_f32 v20, v10, v11
    v_add_f32 v20, v20, v12
    v_add_f32 v20, v20, v13
    v_add_f32 v20, v20, v14
    v_add_f32 v20, v20, v15
    v_add_f32 v20, v20, v16
    v_add_f32 v20, v20, v17
    v_add_f32 v20, v20, v18
    s_nop 1
    v_add_f32_dpp v20, v20, v20 row_ror:8 row_mask:0xf bank_mask:0xf
    s_nop 1
    v_add_f32_dpp v20, v20, v20 row_ror:4 row_mask:0xf bank_mask:0xf
    s_nop 1
    v_add_f32_dpp v20, v20, v20 row_ror:2 row_mask:0xf bank_mask:0xf
    s_nop 1
    v_add_f32_dpp v20, v20, v20 row_ror:1 row_mask:0xf bank_mask:0xf
    s_nop 1
    v_readlane_b32 s20, v20, 0
    v_readlane_b32 s21, v20, 16
    v_readlane_b32 s22, v20, 32
    v_readlane_b32 s23, v20, 48
    s_nop 1
    v_mov_b32 v20, s20
    v_add_f32 v20, s21, v20
    v_add_f32 v20, s22, v20
    v_add_f32 v20, s23, v20
    v_mul_f32 v20, 0x3ae38e39, v20
    v_sub_f32 v22, v10, v20
    v_mul_f32 v21, v22, v22
    v_sub_f32 v22, v11, v20
    v_fmac_f32 v21, v22, v22
    v_sub_f32 v22, v12, v20
    v_fmac_f32 v21, v22, v22
    v_sub_f32 v22, v13, v20
    v_fmac_f32 v21, v22, v22
    v_sub_f32 v22, v14, v20
    v_fmac_f32 v21, v22, v22
    v_sub_f32 v22, v15, v20
    v_fmac_f32 v21, v22, v22
    v_sub_f32 v22, v16, v20
    v_fmac_f32 v21, v22, v22
    v_sub_f32 v22, v17, v20
    v_fmac_f32 v21, v22, v22
    v_sub_f32 v22, v18, v20
    v_fmac_f32 v21, v22, v22
    s_nop 1
    v_add_f32_dpp v21, v21, v21 row_ror:8 row_mask:0xf bank_mask:0xf
    s_nop 1
    v_add_f32_dpp v21, v21, v21 row_ror:4 row_mask:0xf bank_mask:0xf
    s_nop 1
    v_add_f32_dpp v21, v21, v21 row_ror:2 row_mask:0xf bank_mask:0xf
    s_nop 1
    v_add_f32_dpp v21, v21, v21 row_ror:1 row_mask:0xf bank_mask:0xf
    s_nop 1
    v_readlane_b32 s20, v21, 0
    v_readlane_b32 s21, v21, 16
    v_readlane_b32 s22, v21, 32
    v_readlane_b32 s23, v21, 48
    s_nop 1
    v_mov_b32 v21, s20
    v_add_f32 v21, s21, v21
    v_add_f32 v21, s22, v21
    v_add_f32 v21, s23, v21
    v_mul_f32 v21, 0x3ae38e39, v21
    v_cvt_pk_bf16_f32 v20, v20, v20
    v_cvt_pk_bf16_f32 v21, v21, v21
    v_lshlrev_b32 v20, 16, v20
    v_lshlrev_b32 v21, 16, v21
    v_add_f32 v21, 0x3727c5ac, v21
    v_cvt_pk_bf16_f32 v21, v21, v21
    v_lshlrev_b32 v21, 16, v21
    v_sqrt_f32 v21, v21
    s_nop 0
    v_cvt_pk_bf16_f32 v21, v21, v21
    v_lshlrev_b32 v21, 16, v21
    v_rcp_f32 v22, v21
    s_nop 0
    v_fma_f32 v23, -v21, v22, 1.0
    v_fmac_f32 v22, v23, v22
    v_sub_f32 v10, v10, v20
    v_sub_f32 v11, v11, v20
    v_sub_f32 v12, v12, v20
    v_sub_f32 v13, v13, v20
    v_sub_f32 v14, v14, v20
    v_sub_f32 v15, v15, v20
    v_sub_f32 v16, v16, v20
    v_sub_f32 v17, v17, v20
    v_sub_f32 v18, v18, v20
    v_cvt_pk_bf16_f32 v10, v10, v10
    v_cvt_pk_bf16_f32 v11, v11, v11
    v_cvt_pk_bf16_f32 v12, v12, v12
    v_cvt_pk_bf16_f32 v13, v13, v13
    v_cvt_pk_bf16_f32 v14, v14, v14
    v_cvt_pk_bf16_f32 v15, v15, v15
    v_cvt_pk_bf16_f32 v16, v16, v16
    v_cvt_pk_bf16_f32 v17, v17, v17
    v_cvt_pk_bf16_f32 v18, v18, v18
    v_lshlrev_b32 v10, 16, v10
    v_lshlrev_b32 v11, 16, v11
    v_lshlrev_b32 v12, 16, v12
    v_lshlrev_b32 v13, 16, v13
    v_lshlrev_b32 v14, 16, v14
    v_lshlrev_b32 v15, 16, v15
    v_lshlrev_b32 v16, 16, v16
    v_lshlrev_b32 v17, 16, v17
    v_lshlrev_b32 v18, 16, v18
    v_mul_f32 v23, v10, v22
    v_fma_f32 v10, -v21, v23, v10
    v_fma_f32 v10, v10, v22, v23
    v_mul_f32 v23, v11, v22
    v_fma_f32 v11, -v21, v23, v11
    v_fma_f32 v11, v11, v22, v23
    v_mul_f32 v23, v12, v22
    v_fma_f32 v12, -v21, v23, v12
    v_fma_f32 v12, v12, v22, v23
    v_mul_f32 v23, v13, v22
    v_fma_f32 v13, -v21, v23, v13
    v_fma_f32 v13, v13, v22, v23
    v_mul_f32 v23, v14, v22
    v_fma_f32 v14, -v21, v23, v14
    v_fma_f32 v14, v14, v22, v23
    v_mul_f32 v23, v15, v22
    v_fma_f32 v15, -v21, v23, v15
    v_fma_f32 v15, v15, v22, v23
    v_mul_f32 v23, v16, v22
    v_fma_f32 v16, -v21, v23, v16
    v_fma_f32 v16, v16, v22, v23
    v_mul_f32 v23, v17, v22
    v_fma_f32 v17, -v21, v23, v17
    v_fma_f32 v17, v17, v22, v23
    v_mul_f32 v23, v18, v22
    v_fma_f32 v18, -v21, v23, v18
    v_fma_f32 v18, v18, v22, v23
    v_cvt_pk_bf16_f32 v10, v10, v10
    v_cvt_pk_bf16_f32 v11, v11, v11
    v_cvt_pk_bf16_f32 v12, v12, v12
    v_cvt_pk_bf16_f32 v13, v13, v13
    v_cvt_pk_bf16_f32 v14, v14, v14
    v_cvt_pk_bf16_f32 v15, v15, v15
    v_cvt_pk_bf16_f32 v16, v16, v16
    v_cvt_pk_bf16_f32 v17, v17, v17
    v_cvt_pk_bf16_f32 v18, v18, v18
    v_lshlrev_b32 v10, 16, v10
    v_lshlrev_b32 v11, 16, v11
    v_lshlrev_b32 v12, 16, v12
    v_lshlrev_b32 v13, 16, v13
    v_lshlrev_b32 v14, 16, v14
    v_lshlrev_b32 v15, 16, v15
    v_lshlrev_b32 v16, 16, v16
    v_lshlrev_b32 v17, 16, v17
    v_lshlrev_b32 v18, 16, v18
    v_lshlrev_b32 v24, 2, v6
    ds_write_b32 v24, v10 offset:0
    ds_write_b32 v24, v11 offset:256
    ds_write_b32 v24, v12 offset:512
    ds_write_b32 v24, v13 offset:768
    ds_write_b32 v24, v14 offset:1024
    ds_write_b32 v24, v15 offset:1280
    ds_write_b32 v24, v16 offset:1536
    ds_write_b32 v24, v17 offset:1792
    ds_write_b32 v24, v18 offset:2048
    s_waitcnt lgkmcnt(0)
    s_barrier
    v_lshlrev_b32 v25, 2, v3
    ds_read_b32 v10, v25 offset:0
    ds_read_b32 v11, v25 offset:64
    ds_read_b32 v12, v25 offset:128
    ds_read_b32 v13, v25 offset:192
    ds_read_b32 v14, v25 offset:256
    ds_read_b32 v15, v25 offset:320
    ds_read_b32 v16, v25 offset:384
    ds_read_b32 v17, v25 offset:448
    ds_read_b32 v18, v25 offset:512
    v_mov_b32 v70, 0
    v_mov_b32 v71, 0
    v_mov_b32 v72, 0
    v_mov_b32 v73, 0
    v_mov_b32 v74, 0
    v_mov_b32 v75, 0
    v_mov_b32 v76, 0
    v_mov_b32 v77, 0
    s_waitcnt lgkmcnt(0)
    s_waitcnt vmcnt(0)
    v_lshlrev_b32 v80, 16, v32
    v_and_b32 v81, 0xffff0000, v32
    v_fmac_f32 v70, v10, v80
    v_fmac_f32 v71, v10, v81
    v_lshlrev_b32 v80, 16, v33
    v_and_b32 v81, 0xffff0000, v33
    v_fmac_f32 v72, v10, v80
    v_fmac_f32 v73, v10, v81
    v_lshlrev_b32 v80, 16, v34
    v_and_b32 v81, 0xffff0000, v34
    v_fmac_f32 v74, v10, v80
    v_fmac_f32 v75, v10, v81
    v_lshlrev_b32 v80, 16, v35
    v_and_b32 v81, 0xffff0000, v35
    v_fmac_f32 v76, v10, v80
    v_fmac_f32 v77, v10, v81
    s_nop 0
    v_lshlrev_b32 v80, 16, v36
    v_and_b32 v81, 0xffff0000, v36
    v_fmac_f32 v70, v11, v80
    v_fmac_f32 v71, v11, v81
    v_lshlrev_b32 v80, 16, v37
    v_and_b32 v81, 0xffff0000, v37
    v_fmac_f32 v72, v11, v80
    v_fmac_f32 v73, v11, v81
    v_lshlrev_b32 v80, 16, v38
    v_and_b32 v81, 0xffff0000, v38
    v_fmac_f32 v74, v11, v80
    v_fmac_f32 v75, v11, v81
    v_lshlrev_b32 v80, 16, v39
    v_and_b32 v81, 0xffff0000, v39
    v_fmac_f32 v76, v11, v80
    v_fmac_f32 v77, v11, v81
    s_nop 0
    v_lshlrev_b32 v80, 16, v40
    v_and_b32 v81, 0xffff0000, v40
    v_fmac_f32 v70, v12, v80
    v_fmac_f32 v71, v12, v81
    v_lshlrev_b32 v80, 16, v41
    v_and_b32 v81, 0xffff0000, v41
    v_fmac_f32 v72, v12, v80
    v_fmac_f32 v73, v12, v81
    v_lshlrev_b32 v80, 16, v42
    v_and_b32 v81, 0xffff0000, v42
    v_fmac_f32 v74, v12, v80
    v_fmac_f32 v75, v12, v81
    v_lshlrev_b32 v80, 16, v43
    v_and_b32 v81, 0xffff0000, v43
    v_fmac_f32 v76, v12, v80
    v_fmac_f32 v77, v12, v81
    s_nop 0
    v_lshlrev_b32 v80, 16, v44
    v_and_b32 v81, 0xffff0000, v44
    v_fmac_f32 v70, v13, v80
    v_fmac_f32 v71, v13, v81
    v_lshlrev_b32 v80, 16, v45
    v_and_b32 v81, 0xffff0000, v45
    v_fmac_f32 v72, v13, v80
    v_fmac_f32 v73, v13, v81
    v_lshlrev_b32 v80, 16, v46
    v_and_b32 v81, 0xffff0000, v46
    v_fmac_f32 v74, v13, v80
    v_fmac_f32 v75, v13, v81
    v_lshlrev_b32 v80, 16, v47
    v_and_b32 v81, 0xffff0000, v47
    v_fmac_f32 v76, v13, v80
    v_fmac_f32 v77, v13, v81
    s_nop 0
    v_lshlrev_b32 v80, 16, v48
    v_and_b32 v81, 0xffff0000, v48
    v_fmac_f32 v70, v14, v80
    v_fmac_f32 v71, v14, v81
    v_lshlrev_b32 v80, 16, v49
    v_and_b32 v81, 0xffff0000, v49
    v_fmac_f32 v72, v14, v80
    v_fmac_f32 v73, v14, v81
    v_lshlrev_b32 v80, 16, v50
    v_and_b32 v81, 0xffff0000, v50
    v_fmac_f32 v74, v14, v80
    v_fmac_f32 v75, v14, v81
    v_lshlrev_b32 v80, 16, v51
    v_and_b32 v81, 0xffff0000, v51
    v_fmac_f32 v76, v14, v80
    v_fmac_f32 v77, v14, v81
    s_nop 0
    v_lshlrev_b32 v80, 16, v52
    v_and_b32 v81, 0xffff0000, v52
    v_fmac_f32 v70, v15, v80
    v_fmac_f32 v71, v15, v81
    v_lshlrev_b32 v80, 16, v53
    v_and_b32 v81, 0xffff0000, v53
    v_fmac_f32 v72, v15, v80
    v_fmac_f32 v73, v15, v81
    v_lshlrev_b32 v80, 16, v54
    v_and_b32 v81, 0xffff0000, v54
    v_fmac_f32 v74, v15, v80
    v_fmac_f32 v75, v15, v81
    v_lshlrev_b32 v80, 16, v55
    v_and_b32 v81, 0xffff0000, v55
    v_fmac_f32 v76, v15, v80
    v_fmac_f32 v77, v15, v81
    s_nop 0
    v_lshlrev_b32 v80, 16, v56
    v_and_b32 v81, 0xffff0000, v56
    v_fmac_f32 v70, v16, v80
    v_fmac_f32 v71, v16, v81
    v_lshlrev_b32 v80, 16, v57
    v_and_b32 v81, 0xffff0000, v57
    v_fmac_f32 v72, v16, v80
    v_fmac_f32 v73, v16, v81
    v_lshlrev_b32 v80, 16, v58
    v_and_b32 v81, 0xffff0000, v58
    v_fmac_f32 v74, v16, v80
    v_fmac_f32 v75, v16, v81
    v_lshlrev_b32 v80, 16, v59
    v_and_b32 v81, 0xffff0000, v59
    v_fmac_f32 v76, v16, v80
    v_fmac_f32 v77, v16, v81
    s_nop 0
    v_lshlrev_b32 v80, 16, v60
    v_and_b32 v81, 0xffff0000, v60
    v_fmac_f32 v70, v17, v80
    v_fmac_f32 v71, v17, v81
    v_lshlrev_b32 v80, 16, v61
    v_and_b32 v81, 0xffff0000, v61
    v_fmac_f32 v72, v17, v80
    v_fmac_f32 v73, v17, v81
    v_lshlrev_b32 v80, 16, v62
    v_and_b32 v81, 0xffff0000, v62
    v_fmac_f32 v74, v17, v80
    v_fmac_f32 v75, v17, v81
    v_lshlrev_b32 v80, 16, v63
    v_and_b32 v81, 0xffff0000, v63
    v_fmac_f32 v76, v17, v80
    v_fmac_f32 v77, v17, v81
    s_nop 0
    v_lshlrev_b32 v80, 16, v64
    v_and_b32 v81, 0xffff0000, v64
    v_fmac_f32 v70, v18, v80
    v_fmac_f32 v71, v18, v81
    v_lshlrev_b32 v80, 16, v65
    v_and_b32 v81, 0xffff0000, v65
    v_fmac_f32 v72, v18, v80
    v_fmac_f32 v73, v18, v81
    v_lshlrev_b32 v80, 16, v66
    v_and_b32 v81, 0xffff0000, v66
    v_fmac_f32 v74, v18, v80
    v_fmac_f32 v75, v18, v81
    v_lshlrev_b32 v80, 16, v67
    v_and_b32 v81, 0xffff0000, v67
    v_fmac_f32 v76, v18, v80
    v_fmac_f32 v77, v18, v81
    v_lshlrev_b32 v26, 9, v2
    v_lshl_add_u32 v26, v1, 5, v26
    ds_write_b128 v26, v[70:73] offset:2304
    ds_write_b128 v26, v[74:77] offset:2320
    s_waitcnt lgkmcnt(0)
    s_barrier
    v_cmp_gt_u32 vcc, 128, v0
    s_and_saveexec_b64 s[16:17], vcc
    s_cbranch_execz K1_END
    v_lshlrev_b32 v27, 2, v0

    ds_read_b32 v32, v27 offset:2304
    ds_read_b32 v33, v27 offset:2816
    ds_read_b32 v34, v27 offset:3328
    ds_read_b32 v35, v27 offset:3840
    ds_read_b32 v36, v27 offset:4352
    ds_read_b32 v37, v27 offset:4864
    ds_read_b32 v38, v27 offset:5376
    ds_read_b32 v39, v27 offset:5888
    ds_read_b32 v40, v27 offset:6400
    ds_read_b32 v41, v27 offset:6912
    ds_read_b32 v42, v27 offset:7424
    ds_read_b32 v43, v27 offset:7936
    ds_read_b32 v44, v27 offset:8448
    ds_read_b32 v45, v27 offset:8960
    ds_read_b32 v46, v27 offset:9472
    ds_read_b32 v47, v27 offset:9984
    s_waitcnt lgkmcnt(0)
    v_add_f32 v32, v32, v33
    v_add_f32 v32, v32, v34
    v_add_f32 v32, v32, v35
    v_add_f32 v32, v32, v36
    v_add_f32 v32, v32, v37
    v_add_f32 v32, v32, v38
    v_add_f32 v32, v32, v39
    v_add_f32 v32, v32, v40
    v_add_f32 v32, v32, v41
    v_add_f32 v32, v32, v42
    v_add_f32 v32, v32, v43
    v_add_f32 v32, v32, v44
    v_add_f32 v32, v32, v45
    v_add_f32 v32, v32, v46
    v_add_f32 v32, v32, v47
    s_lshl_b32 s14, s11, 14
    s_lshl_b32 s15, s10, 9
    s_add_u32 s14, s14, s15
    v_add_u32 v27, s14, v27
    global_store_dword v27, v32, s[8:9]

K1_END:
    s_endpgm
.p2align 8
.globl k2_attn_kernel
.type k2_attn_kernel,@function
k2_attn_kernel:
    s_cmp_ge_u32 s2, 256
    s_cbranch_scc1 K2_END
    s_load_dwordx2 s[4:5], s[0:1], 8
    s_load_dwordx2 s[6:7], s[0:1], 16
    s_load_dwordx2 s[8:9], s[0:1], 96
    s_load_dwordx2 s[18:19], s[0:1], 0
    s_load_dwordx2 s[20:21], s[0:1], 24
    s_lshr_b32 s10, s2, 4
    s_and_b32 s11, s2, 15
    s_lshl_b32 s12, s10, 24
    s_lshl_b32 s13, s11, 16
    s_add_u32 s12, s12, s13
    s_add_u32 s12, s12, 0xf00000
    v_and_b32 v1, 63, v0
    v_lshlrev_b32 v1, 4, v1
    v_lshrrev_b32 v2, 6, v0
    v_lshl_add_u32 v1, v2, 13, v1
    v_add_u32 v1, s12, v1
    v_add_u32 v2, 0x1000, v1
    v_and_b32 v3, 15, v0
    v_lshlrev_b32 v4, 5, v3
    s_lshl_b32 s14, s10, 10
    v_add_u32 v4, s14, v4
    s_waitcnt lgkmcnt(0)

    global_load_dwordx4 v[96:99], v4, s[8:9] offset:0
    global_load_dwordx4 v[100:103], v4, s[8:9] offset:16
    global_load_dwordx4 v[104:107], v4, s[8:9] offset:512
    global_load_dwordx4 v[108:111], v4, s[8:9] offset:528
    v_add_u32 v4, 0x4000, v4
    global_load_dwordx4 v[112:115], v4, s[8:9] offset:0
    global_load_dwordx4 v[116:119], v4, s[8:9] offset:16
    global_load_dwordx4 v[120:123], v4, s[8:9] offset:512
    global_load_dwordx4 v[124:127], v4, s[8:9] offset:528
    v_add_u32 v4, 0x4000, v4
    global_load_dwordx4 v[128:131], v4, s[8:9] offset:0
    global_load_dwordx4 v[132:135], v4, s[8:9] offset:16
    global_load_dwordx4 v[136:139], v4, s[8:9] offset:512
    global_load_dwordx4 v[140:143], v4, s[8:9] offset:528
    v_add_u32 v4, 0x4000, v4
    global_load_dwordx4 v[144:147], v4, s[8:9] offset:0
    global_load_dwordx4 v[148:151], v4, s[8:9] offset:16
    global_load_dwordx4 v[152:155], v4, s[8:9] offset:512
    global_load_dwordx4 v[156:159], v4, s[8:9] offset:528
    global_load_dwordx4 v[32:35], v1, s[4:5] offset:0 nt
    global_load_dwordx4 v[36:39], v1, s[4:5] offset:1024 nt
    global_load_dwordx4 v[40:43], v1, s[4:5] offset:2048 nt
    global_load_dwordx4 v[44:47], v1, s[4:5] offset:3072 nt
    global_load_dwordx4 v[48:51], v2, s[4:5] offset:0 nt
    global_load_dwordx4 v[52:55], v2, s[4:5] offset:1024 nt
    global_load_dwordx4 v[56:59], v2, s[4:5] offset:2048 nt
    global_load_dwordx4 v[60:63], v2, s[4:5] offset:3072 nt
    global_load_dwordx4 v[64:67], v1, s[6:7] offset:0 nt
    global_load_dwordx4 v[68:71], v1, s[6:7] offset:1024 nt
    global_load_dwordx4 v[72:75], v1, s[6:7] offset:2048 nt
    global_load_dwordx4 v[76:79], v1, s[6:7] offset:3072 nt
    global_load_dwordx4 v[80:83], v2, s[6:7] offset:0 nt
    global_load_dwordx4 v[84:87], v2, s[6:7] offset:1024 nt
    global_load_dwordx4 v[88:91], v2, s[6:7] offset:2048 nt
    global_load_dwordx4 v[92:95], v2, s[6:7] offset:3072 nt
    s_waitcnt vmcnt(16)
    v_add_f32 v96, v96, v112
    v_add_f32 v97, v97, v113
    v_add_f32 v98, v98, v114
    v_add_f32 v99, v99, v115
    v_add_f32 v96, v96, v128
    v_add_f32 v97, v97, v129
    v_add_f32 v98, v98, v130
    v_add_f32 v99, v99, v131
    v_add_f32 v96, v96, v144
    v_add_f32 v97, v97, v145
    v_add_f32 v98, v98, v146
    v_add_f32 v99, v99, v147
    v_cvt_pk_bf16_f32 v10, v96, v97
    v_cvt_pk_bf16_f32 v11, v98, v99
    v_add_f32 v100, v100, v116
    v_add_f32 v101, v101, v117
    v_add_f32 v102, v102, v118
    v_add_f32 v103, v103, v119
    v_add_f32 v100, v100, v132
    v_add_f32 v101, v101, v133
    v_add_f32 v102, v102, v134
    v_add_f32 v103, v103, v135
    v_add_f32 v100, v100, v148
    v_add_f32 v101, v101, v149
    v_add_f32 v102, v102, v150
    v_add_f32 v103, v103, v151
    v_cvt_pk_bf16_f32 v12, v100, v101
    v_cvt_pk_bf16_f32 v13, v102, v103
    v_add_f32 v104, v104, v120
    v_add_f32 v105, v105, v121
    v_add_f32 v106, v106, v122
    v_add_f32 v107, v107, v123
    v_add_f32 v104, v104, v136
    v_add_f32 v105, v105, v137
    v_add_f32 v106, v106, v138
    v_add_f32 v107, v107, v139
    v_add_f32 v104, v104, v152
    v_add_f32 v105, v105, v153
    v_add_f32 v106, v106, v154
    v_add_f32 v107, v107, v155
    v_cvt_pk_bf16_f32 v14, v104, v105
    v_cvt_pk_bf16_f32 v15, v106, v107
    v_add_f32 v108, v108, v124
    v_add_f32 v109, v109, v125
    v_add_f32 v110, v110, v126
    v_add_f32 v111, v111, v127
    v_add_f32 v108, v108, v140
    v_add_f32 v109, v109, v141
    v_add_f32 v110, v110, v142
    v_add_f32 v111, v111, v143
    v_add_f32 v108, v108, v156
    v_add_f32 v109, v109, v157
    v_add_f32 v110, v110, v158
    v_add_f32 v111, v111, v159
    v_cvt_pk_bf16_f32 v16, v108, v109
    v_cvt_pk_bf16_f32 v17, v110, v111
    s_waitcnt vmcnt(15)
    v_mov_b32 v100, 0
    v_dot2c_f32_bf16 v100, v32, v10
    v_dot2c_f32_bf16 v100, v33, v11
    v_dot2c_f32_bf16 v100, v34, v12
    v_dot2c_f32_bf16 v100, v35, v13
    v_mov_b32 v108, 0
    v_dot2c_f32_bf16 v108, v32, v14
    v_dot2c_f32_bf16 v108, v33, v15
    v_dot2c_f32_bf16 v108, v34, v16
    v_dot2c_f32_bf16 v108, v35, v17
    s_waitcnt vmcnt(14)
    v_mov_b32 v101, 0
    v_dot2c_f32_bf16 v101, v36, v10
    v_dot2c_f32_bf16 v101, v37, v11
    v_dot2c_f32_bf16 v101, v38, v12
    v_dot2c_f32_bf16 v101, v39, v13
    v_mov_b32 v109, 0
    v_dot2c_f32_bf16 v109, v36, v14
    v_dot2c_f32_bf16 v109, v37, v15
    v_dot2c_f32_bf16 v109, v38, v16
    v_dot2c_f32_bf16 v109, v39, v17
    s_waitcnt vmcnt(13)
    v_mov_b32 v102, 0
    v_dot2c_f32_bf16 v102, v40, v10
    v_dot2c_f32_bf16 v102, v41, v11
    v_dot2c_f32_bf16 v102, v42, v12
    v_dot2c_f32_bf16 v102, v43, v13
    v_mov_b32 v110, 0
    v_dot2c_f32_bf16 v110, v40, v14
    v_dot2c_f32_bf16 v110, v41, v15
    v_dot2c_f32_bf16 v110, v42, v16
    v_dot2c_f32_bf16 v110, v43, v17
    s_waitcnt vmcnt(12)
    v_mov_b32 v103, 0
    v_dot2c_f32_bf16 v103, v44, v10
    v_dot2c_f32_bf16 v103, v45, v11
    v_dot2c_f32_bf16 v103, v46, v12
    v_dot2c_f32_bf16 v103, v47, v13
    v_mov_b32 v111, 0
    v_dot2c_f32_bf16 v111, v44, v14
    v_dot2c_f32_bf16 v111, v45, v15
    v_dot2c_f32_bf16 v111, v46, v16
    v_dot2c_f32_bf16 v111, v47, v17
    s_waitcnt vmcnt(11)
    v_mov_b32 v104, 0
    v_dot2c_f32_bf16 v104, v48, v10
    v_dot2c_f32_bf16 v104, v49, v11
    v_dot2c_f32_bf16 v104, v50, v12
    v_dot2c_f32_bf16 v104, v51, v13
    v_mov_b32 v112, 0
    v_dot2c_f32_bf16 v112, v48, v14
    v_dot2c_f32_bf16 v112, v49, v15
    v_dot2c_f32_bf16 v112, v50, v16
    v_dot2c_f32_bf16 v112, v51, v17
    s_waitcnt vmcnt(10)
    v_mov_b32 v105, 0
    v_dot2c_f32_bf16 v105, v52, v10
    v_dot2c_f32_bf16 v105, v53, v11
    v_dot2c_f32_bf16 v105, v54, v12
    v_dot2c_f32_bf16 v105, v55, v13
    v_mov_b32 v113, 0
    v_dot2c_f32_bf16 v113, v52, v14
    v_dot2c_f32_bf16 v113, v53, v15
    v_dot2c_f32_bf16 v113, v54, v16
    v_dot2c_f32_bf16 v113, v55, v17
    s_waitcnt vmcnt(9)
    v_mov_b32 v106, 0
    v_dot2c_f32_bf16 v106, v56, v10
    v_dot2c_f32_bf16 v106, v57, v11
    v_dot2c_f32_bf16 v106, v58, v12
    v_dot2c_f32_bf16 v106, v59, v13
    v_mov_b32 v114, 0
    v_dot2c_f32_bf16 v114, v56, v14
    v_dot2c_f32_bf16 v114, v57, v15
    v_dot2c_f32_bf16 v114, v58, v16
    v_dot2c_f32_bf16 v114, v59, v17
    s_waitcnt vmcnt(8)
    v_mov_b32 v107, 0
    v_dot2c_f32_bf16 v107, v60, v10
    v_dot2c_f32_bf16 v107, v61, v11
    v_dot2c_f32_bf16 v107, v62, v12
    v_dot2c_f32_bf16 v107, v63, v13
    v_mov_b32 v115, 0
    v_dot2c_f32_bf16 v115, v60, v14
    v_dot2c_f32_bf16 v115, v61, v15
    v_dot2c_f32_bf16 v115, v62, v16
    v_dot2c_f32_bf16 v115, v63, v17
    s_nop 1
    v_add_f32_dpp v100, v100, v100 row_ror:8 row_mask:0xf bank_mask:0xf
    v_add_f32_dpp v101, v101, v101 row_ror:8 row_mask:0xf bank_mask:0xf
    v_add_f32_dpp v102, v102, v102 row_ror:8 row_mask:0xf bank_mask:0xf
    v_add_f32_dpp v103, v103, v103 row_ror:8 row_mask:0xf bank_mask:0xf
    v_add_f32_dpp v104, v104, v104 row_ror:8 row_mask:0xf bank_mask:0xf
    v_add_f32_dpp v105, v105, v105 row_ror:8 row_mask:0xf bank_mask:0xf
    v_add_f32_dpp v106, v106, v106 row_ror:8 row_mask:0xf bank_mask:0xf
    v_add_f32_dpp v107, v107, v107 row_ror:8 row_mask:0xf bank_mask:0xf
    v_add_f32_dpp v108, v108, v108 row_ror:8 row_mask:0xf bank_mask:0xf
    v_add_f32_dpp v109, v109, v109 row_ror:8 row_mask:0xf bank_mask:0xf
    v_add_f32_dpp v110, v110, v110 row_ror:8 row_mask:0xf bank_mask:0xf
    v_add_f32_dpp v111, v111, v111 row_ror:8 row_mask:0xf bank_mask:0xf
    v_add_f32_dpp v112, v112, v112 row_ror:8 row_mask:0xf bank_mask:0xf
    v_add_f32_dpp v113, v113, v113 row_ror:8 row_mask:0xf bank_mask:0xf
    v_add_f32_dpp v114, v114, v114 row_ror:8 row_mask:0xf bank_mask:0xf
    v_add_f32_dpp v115, v115, v115 row_ror:8 row_mask:0xf bank_mask:0xf
    s_nop 1
    v_add_f32_dpp v100, v100, v100 row_ror:4 row_mask:0xf bank_mask:0xf
    v_add_f32_dpp v101, v101, v101 row_ror:4 row_mask:0xf bank_mask:0xf
    v_add_f32_dpp v102, v102, v102 row_ror:4 row_mask:0xf bank_mask:0xf
    v_add_f32_dpp v103, v103, v103 row_ror:4 row_mask:0xf bank_mask:0xf
    v_add_f32_dpp v104, v104, v104 row_ror:4 row_mask:0xf bank_mask:0xf
    v_add_f32_dpp v105, v105, v105 row_ror:4 row_mask:0xf bank_mask:0xf
    v_add_f32_dpp v106, v106, v106 row_ror:4 row_mask:0xf bank_mask:0xf
    v_add_f32_dpp v107, v107, v107 row_ror:4 row_mask:0xf bank_mask:0xf
    v_add_f32_dpp v108, v108, v108 row_ror:4 row_mask:0xf bank_mask:0xf
    v_add_f32_dpp v109, v109, v109 row_ror:4 row_mask:0xf bank_mask:0xf
    v_add_f32_dpp v110, v110, v110 row_ror:4 row_mask:0xf bank_mask:0xf
    v_add_f32_dpp v111, v111, v111 row_ror:4 row_mask:0xf bank_mask:0xf
    v_add_f32_dpp v112, v112, v112 row_ror:4 row_mask:0xf bank_mask:0xf
    v_add_f32_dpp v113, v113, v113 row_ror:4 row_mask:0xf bank_mask:0xf
    v_add_f32_dpp v114, v114, v114 row_ror:4 row_mask:0xf bank_mask:0xf
    v_add_f32_dpp v115, v115, v115 row_ror:4 row_mask:0xf bank_mask:0xf
    s_nop 1
    v_add_f32_dpp v100, v100, v100 row_ror:2 row_mask:0xf bank_mask:0xf
    v_add_f32_dpp v101, v101, v101 row_ror:2 row_mask:0xf bank_mask:0xf
    v_add_f32_dpp v102, v102, v102 row_ror:2 row_mask:0xf bank_mask:0xf
    v_add_f32_dpp v103, v103, v103 row_ror:2 row_mask:0xf bank_mask:0xf
    v_add_f32_dpp v104, v104, v104 row_ror:2 row_mask:0xf bank_mask:0xf
    v_add_f32_dpp v105, v105, v105 row_ror:2 row_mask:0xf bank_mask:0xf
    v_add_f32_dpp v106, v106, v106 row_ror:2 row_mask:0xf bank_mask:0xf
    v_add_f32_dpp v107, v107, v107 row_ror:2 row_mask:0xf bank_mask:0xf
    v_add_f32_dpp v108, v108, v108 row_ror:2 row_mask:0xf bank_mask:0xf
    v_add_f32_dpp v109, v109, v109 row_ror:2 row_mask:0xf bank_mask:0xf
    v_add_f32_dpp v110, v110, v110 row_ror:2 row_mask:0xf bank_mask:0xf
    v_add_f32_dpp v111, v111, v111 row_ror:2 row_mask:0xf bank_mask:0xf
    v_add_f32_dpp v112, v112, v112 row_ror:2 row_mask:0xf bank_mask:0xf
    v_add_f32_dpp v113, v113, v113 row_ror:2 row_mask:0xf bank_mask:0xf
    v_add_f32_dpp v114, v114, v114 row_ror:2 row_mask:0xf bank_mask:0xf
    v_add_f32_dpp v115, v115, v115 row_ror:2 row_mask:0xf bank_mask:0xf
    s_nop 1
    v_add_f32_dpp v100, v100, v100 row_ror:1 row_mask:0xf bank_mask:0xf
    v_add_f32_dpp v101, v101, v101 row_ror:1 row_mask:0xf bank_mask:0xf
    v_add_f32_dpp v102, v102, v102 row_ror:1 row_mask:0xf bank_mask:0xf
    v_add_f32_dpp v103, v103, v103 row_ror:1 row_mask:0xf bank_mask:0xf
    v_add_f32_dpp v104, v104, v104 row_ror:1 row_mask:0xf bank_mask:0xf
    v_add_f32_dpp v105, v105, v105 row_ror:1 row_mask:0xf bank_mask:0xf
    v_add_f32_dpp v106, v106, v106 row_ror:1 row_mask:0xf bank_mask:0xf
    v_add_f32_dpp v107, v107, v107 row_ror:1 row_mask:0xf bank_mask:0xf
    v_add_f32_dpp v108, v108, v108 row_ror:1 row_mask:0xf bank_mask:0xf
    v_add_f32_dpp v109, v109, v109 row_ror:1 row_mask:0xf bank_mask:0xf
    v_add_f32_dpp v110, v110, v110 row_ror:1 row_mask:0xf bank_mask:0xf
    v_add_f32_dpp v111, v111, v111 row_ror:1 row_mask:0xf bank_mask:0xf
    v_add_f32_dpp v112, v112, v112 row_ror:1 row_mask:0xf bank_mask:0xf
    v_add_f32_dpp v113, v113, v113 row_ror:1 row_mask:0xf bank_mask:0xf
    v_add_f32_dpp v114, v114, v114 row_ror:1 row_mask:0xf bank_mask:0xf
    v_add_f32_dpp v115, v115, v115 row_ror:1 row_mask:0xf bank_mask:0xf
    v_cvt_pk_bf16_f32 v100, v100, v100
    v_cvt_pk_bf16_f32 v101, v101, v101
    v_cvt_pk_bf16_f32 v102, v102, v102
    v_cvt_pk_bf16_f32 v103, v103, v103
    v_cvt_pk_bf16_f32 v104, v104, v104
    v_cvt_pk_bf16_f32 v105, v105, v105
    v_cvt_pk_bf16_f32 v106, v106, v106
    v_cvt_pk_bf16_f32 v107, v107, v107
    v_cvt_pk_bf16_f32 v108, v108, v108
    v_cvt_pk_bf16_f32 v109, v109, v109
    v_cvt_pk_bf16_f32 v110, v110, v110
    v_cvt_pk_bf16_f32 v111, v111, v111
    v_cvt_pk_bf16_f32 v112, v112, v112
    v_cvt_pk_bf16_f32 v113, v113, v113
    v_cvt_pk_bf16_f32 v114, v114, v114
    v_cvt_pk_bf16_f32 v115, v115, v115
    v_lshlrev_b32 v100, 16, v100
    v_lshlrev_b32 v101, 16, v101
    v_lshlrev_b32 v102, 16, v102
    v_lshlrev_b32 v103, 16, v103
    v_lshlrev_b32 v104, 16, v104
    v_lshlrev_b32 v105, 16, v105
    v_lshlrev_b32 v106, 16, v106
    v_lshlrev_b32 v107, 16, v107
    v_lshlrev_b32 v108, 16, v108
    v_lshlrev_b32 v109, 16, v109
    v_lshlrev_b32 v110, 16, v110
    v_lshlrev_b32 v111, 16, v111
    v_lshlrev_b32 v112, 16, v112
    v_lshlrev_b32 v113, 16, v113
    v_lshlrev_b32 v114, 16, v114
    v_lshlrev_b32 v115, 16, v115
    v_mul_f32 v100, 0x3db504f3, v100
    v_mul_f32 v101, 0x3db504f3, v101
    v_mul_f32 v102, 0x3db504f3, v102
    v_mul_f32 v103, 0x3db504f3, v103
    v_mul_f32 v104, 0x3db504f3, v104
    v_mul_f32 v105, 0x3db504f3, v105
    v_mul_f32 v106, 0x3db504f3, v106
    v_mul_f32 v107, 0x3db504f3, v107
    v_mul_f32 v108, 0x3db504f3, v108
    v_mul_f32 v109, 0x3db504f3, v109
    v_mul_f32 v110, 0x3db504f3, v110
    v_mul_f32 v111, 0x3db504f3, v111
    v_mul_f32 v112, 0x3db504f3, v112
    v_mul_f32 v113, 0x3db504f3, v113
    v_mul_f32 v114, 0x3db504f3, v114
    v_mul_f32 v115, 0x3db504f3, v115
    v_cvt_pk_bf16_f32 v100, v100, v100
    v_cvt_pk_bf16_f32 v101, v101, v101
    v_cvt_pk_bf16_f32 v102, v102, v102
    v_cvt_pk_bf16_f32 v103, v103, v103
    v_cvt_pk_bf16_f32 v104, v104, v104
    v_cvt_pk_bf16_f32 v105, v105, v105
    v_cvt_pk_bf16_f32 v106, v106, v106
    v_cvt_pk_bf16_f32 v107, v107, v107
    v_cvt_pk_bf16_f32 v108, v108, v108
    v_cvt_pk_bf16_f32 v109, v109, v109
    v_cvt_pk_bf16_f32 v110, v110, v110
    v_cvt_pk_bf16_f32 v111, v111, v111
    v_cvt_pk_bf16_f32 v112, v112, v112
    v_cvt_pk_bf16_f32 v113, v113, v113
    v_cvt_pk_bf16_f32 v114, v114, v114
    v_cvt_pk_bf16_f32 v115, v115, v115
    v_lshlrev_b32 v100, 16, v100
    v_lshlrev_b32 v101, 16, v101
    v_lshlrev_b32 v102, 16, v102
    v_lshlrev_b32 v103, 16, v103
    v_lshlrev_b32 v104, 16, v104
    v_lshlrev_b32 v105, 16, v105
    v_lshlrev_b32 v106, 16, v106
    v_lshlrev_b32 v107, 16, v107
    v_lshlrev_b32 v108, 16, v108
    v_lshlrev_b32 v109, 16, v109
    v_lshlrev_b32 v110, 16, v110
    v_lshlrev_b32 v111, 16, v111
    v_lshlrev_b32 v112, 16, v112
    v_lshlrev_b32 v113, 16, v113
    v_lshlrev_b32 v114, 16, v114
    v_lshlrev_b32 v115, 16, v115
    v_max3_f32 v20, v100, v101, v102
    v_max3_f32 v20, v20, v103, v104
    v_max3_f32 v20, v20, v105, v106
    v_max_f32 v20, v20, v107
    v_max3_f32 v21, v108, v109, v110
    v_max3_f32 v21, v21, v111, v112
    v_max3_f32 v21, v21, v113, v114
    v_max_f32 v21, v21, v115
    v_sub_f32 v100, v100, v20
    v_mul_f32 v100, 0x3fb8aa3b, v100
    v_exp_f32 v100, v100
    v_sub_f32 v101, v101, v20
    v_mul_f32 v101, 0x3fb8aa3b, v101
    v_exp_f32 v101, v101
    v_sub_f32 v102, v102, v20
    v_mul_f32 v102, 0x3fb8aa3b, v102
    v_exp_f32 v102, v102
    v_sub_f32 v103, v103, v20
    v_mul_f32 v103, 0x3fb8aa3b, v103
    v_exp_f32 v103, v103
    v_sub_f32 v104, v104, v20
    v_mul_f32 v104, 0x3fb8aa3b, v104
    v_exp_f32 v104, v104
    v_sub_f32 v105, v105, v20
    v_mul_f32 v105, 0x3fb8aa3b, v105
    v_exp_f32 v105, v105
    v_sub_f32 v106, v106, v20
    v_mul_f32 v106, 0x3fb8aa3b, v106
    v_exp_f32 v106, v106
    v_sub_f32 v107, v107, v20
    v_mul_f32 v107, 0x3fb8aa3b, v107
    v_exp_f32 v107, v107
    v_sub_f32 v108, v108, v21
    v_mul_f32 v108, 0x3fb8aa3b, v108
    v_exp_f32 v108, v108
    v_sub_f32 v109, v109, v21
    v_mul_f32 v109, 0x3fb8aa3b, v109
    v_exp_f32 v109, v109
    v_sub_f32 v110, v110, v21
    v_mul_f32 v110, 0x3fb8aa3b, v110
    v_exp_f32 v110, v110
    v_sub_f32 v111, v111, v21
    v_mul_f32 v111, 0x3fb8aa3b, v111
    v_exp_f32 v111, v111
    v_sub_f32 v112, v112, v21
    v_mul_f32 v112, 0x3fb8aa3b, v112
    v_exp_f32 v112, v112
    v_sub_f32 v113, v113, v21
    v_mul_f32 v113, 0x3fb8aa3b, v113
    v_exp_f32 v113, v113
    v_sub_f32 v114, v114, v21
    v_mul_f32 v114, 0x3fb8aa3b, v114
    v_exp_f32 v114, v114
    v_sub_f32 v115, v115, v21
    v_mul_f32 v115, 0x3fb8aa3b, v115
    v_exp_f32 v115, v115
    s_nop 0
    v_add_f32 v22, v100, v101
    v_add_f32 v22, v22, v102
    v_add_f32 v22, v22, v103
    v_add_f32 v22, v22, v104
    v_add_f32 v22, v22, v105
    v_add_f32 v22, v22, v106
    v_add_f32 v22, v22, v107
    v_add_f32 v23, v108, v109
    v_add_f32 v23, v23, v110
    v_add_f32 v23, v23, v111
    v_add_f32 v23, v23, v112
    v_add_f32 v23, v23, v113
    v_add_f32 v23, v23, v114
    v_add_f32 v23, v23, v115
    v_mov_b32 v120, 0
    v_mov_b32 v121, 0
    v_mov_b32 v122, 0
    v_mov_b32 v123, 0
    v_mov_b32 v124, 0
    v_mov_b32 v125, 0
    v_mov_b32 v126, 0
    v_mov_b32 v127, 0
    v_mov_b32 v128, 0
    v_mov_b32 v129, 0
    v_mov_b32 v130, 0
    v_mov_b32 v131, 0
    v_mov_b32 v132, 0
    v_mov_b32 v133, 0
    v_mov_b32 v134, 0
    v_mov_b32 v135, 0
    s_waitcnt vmcnt(7)
    v_lshlrev_b32 v140, 16, v64
    v_and_b32 v141, 0xffff0000, v64
    v_fmac_f32 v120, v100, v140
    v_fmac_f32 v121, v100, v141
    v_fmac_f32 v128, v108, v140
    v_fmac_f32 v129, v108, v141
    v_lshlrev_b32 v140, 16, v65
    v_and_b32 v141, 0xffff0000, v65
    v_fmac_f32 v122, v100, v140
    v_fmac_f32 v123, v100, v141
    v_fmac_f32 v130, v108, v140
    v_fmac_f32 v131, v108, v141
    v_lshlrev_b32 v140, 16, v66
    v_and_b32 v141, 0xffff0000, v66
    v_fmac_f32 v124, v100, v140
    v_fmac_f32 v125, v100, v141
    v_fmac_f32 v132, v108, v140
    v_fmac_f32 v133, v108, v141
    v_lshlrev_b32 v140, 16, v67
    v_and_b32 v141, 0xffff0000, v67
    v_fmac_f32 v126, v100, v140
    v_fmac_f32 v127, v100, v141
    v_fmac_f32 v134, v108, v140
    v_fmac_f32 v135, v108, v141
    s_waitcnt vmcnt(6)
    v_lshlrev_b32 v140, 16, v68
    v_and_b32 v141, 0xffff0000, v68
    v_fmac_f32 v120, v101, v140
    v_fmac_f32 v121, v101, v141
    v_fmac_f32 v128, v109, v140
    v_fmac_f32 v129, v109, v141
    v_lshlrev_b32 v140, 16, v69
    v_and_b32 v141, 0xffff0000, v69
    v_fmac_f32 v122, v101, v140
    v_fmac_f32 v123, v101, v141
    v_fmac_f32 v130, v109, v140
    v_fmac_f32 v131, v109, v141
    v_lshlrev_b32 v140, 16, v70
    v_and_b32 v141, 0xffff0000, v70
    v_fmac_f32 v124, v101, v140
    v_fmac_f32 v125, v101, v141
    v_fmac_f32 v132, v109, v140
    v_fmac_f32 v133, v109, v141
    v_lshlrev_b32 v140, 16, v71
    v_and_b32 v141, 0xffff0000, v71
    v_fmac_f32 v126, v101, v140
    v_fmac_f32 v127, v101, v141
    v_fmac_f32 v134, v109, v140
    v_fmac_f32 v135, v109, v141
    s_waitcnt vmcnt(5)
    v_lshlrev_b32 v140, 16, v72
    v_and_b32 v141, 0xffff0000, v72
    v_fmac_f32 v120, v102, v140
    v_fmac_f32 v121, v102, v141
    v_fmac_f32 v128, v110, v140
    v_fmac_f32 v129, v110, v141
    v_lshlrev_b32 v140, 16, v73
    v_and_b32 v141, 0xffff0000, v73
    v_fmac_f32 v122, v102, v140
    v_fmac_f32 v123, v102, v141
    v_fmac_f32 v130, v110, v140
    v_fmac_f32 v131, v110, v141
    v_lshlrev_b32 v140, 16, v74
    v_and_b32 v141, 0xffff0000, v74
    v_fmac_f32 v124, v102, v140
    v_fmac_f32 v125, v102, v141
    v_fmac_f32 v132, v110, v140
    v_fmac_f32 v133, v110, v141
    v_lshlrev_b32 v140, 16, v75
    v_and_b32 v141, 0xffff0000, v75
    v_fmac_f32 v126, v102, v140
    v_fmac_f32 v127, v102, v141
    v_fmac_f32 v134, v110, v140
    v_fmac_f32 v135, v110, v141
    s_waitcnt vmcnt(4)
    v_lshlrev_b32 v140, 16, v76
    v_and_b32 v141, 0xffff0000, v76
    v_fmac_f32 v120, v103, v140
    v_fmac_f32 v121, v103, v141
    v_fmac_f32 v128, v111, v140
    v_fmac_f32 v129, v111, v141
    v_lshlrev_b32 v140, 16, v77
    v_and_b32 v141, 0xffff0000, v77
    v_fmac_f32 v122, v103, v140
    v_fmac_f32 v123, v103, v141
    v_fmac_f32 v130, v111, v140
    v_fmac_f32 v131, v111, v141
    v_lshlrev_b32 v140, 16, v78
    v_and_b32 v141, 0xffff0000, v78
    v_fmac_f32 v124, v103, v140
    v_fmac_f32 v125, v103, v141
    v_fmac_f32 v132, v111, v140
    v_fmac_f32 v133, v111, v141
    v_lshlrev_b32 v140, 16, v79
    v_and_b32 v141, 0xffff0000, v79
    v_fmac_f32 v126, v103, v140
    v_fmac_f32 v127, v103, v141
    v_fmac_f32 v134, v111, v140
    v_fmac_f32 v135, v111, v141
    s_waitcnt vmcnt(3)
    v_lshlrev_b32 v140, 16, v80
    v_and_b32 v141, 0xffff0000, v80
    v_fmac_f32 v120, v104, v140
    v_fmac_f32 v121, v104, v141
    v_fmac_f32 v128, v112, v140
    v_fmac_f32 v129, v112, v141
    v_lshlrev_b32 v140, 16, v81
    v_and_b32 v141, 0xffff0000, v81
    v_fmac_f32 v122, v104, v140
    v_fmac_f32 v123, v104, v141
    v_fmac_f32 v130, v112, v140
    v_fmac_f32 v131, v112, v141
    v_lshlrev_b32 v140, 16, v82
    v_and_b32 v141, 0xffff0000, v82
    v_fmac_f32 v124, v104, v140
    v_fmac_f32 v125, v104, v141
    v_fmac_f32 v132, v112, v140
    v_fmac_f32 v133, v112, v141
    v_lshlrev_b32 v140, 16, v83
    v_and_b32 v141, 0xffff0000, v83
    v_fmac_f32 v126, v104, v140
    v_fmac_f32 v127, v104, v141
    v_fmac_f32 v134, v112, v140
    v_fmac_f32 v135, v112, v141
    s_waitcnt vmcnt(2)
    v_lshlrev_b32 v140, 16, v84
    v_and_b32 v141, 0xffff0000, v84
    v_fmac_f32 v120, v105, v140
    v_fmac_f32 v121, v105, v141
    v_fmac_f32 v128, v113, v140
    v_fmac_f32 v129, v113, v141
    v_lshlrev_b32 v140, 16, v85
    v_and_b32 v141, 0xffff0000, v85
    v_fmac_f32 v122, v105, v140
    v_fmac_f32 v123, v105, v141
    v_fmac_f32 v130, v113, v140
    v_fmac_f32 v131, v113, v141
    v_lshlrev_b32 v140, 16, v86
    v_and_b32 v141, 0xffff0000, v86
    v_fmac_f32 v124, v105, v140
    v_fmac_f32 v125, v105, v141
    v_fmac_f32 v132, v113, v140
    v_fmac_f32 v133, v113, v141
    v_lshlrev_b32 v140, 16, v87
    v_and_b32 v141, 0xffff0000, v87
    v_fmac_f32 v126, v105, v140
    v_fmac_f32 v127, v105, v141
    v_fmac_f32 v134, v113, v140
    v_fmac_f32 v135, v113, v141
    s_waitcnt vmcnt(1)
    v_lshlrev_b32 v140, 16, v88
    v_and_b32 v141, 0xffff0000, v88
    v_fmac_f32 v120, v106, v140
    v_fmac_f32 v121, v106, v141
    v_fmac_f32 v128, v114, v140
    v_fmac_f32 v129, v114, v141
    v_lshlrev_b32 v140, 16, v89
    v_and_b32 v141, 0xffff0000, v89
    v_fmac_f32 v122, v106, v140
    v_fmac_f32 v123, v106, v141
    v_fmac_f32 v130, v114, v140
    v_fmac_f32 v131, v114, v141
    v_lshlrev_b32 v140, 16, v90
    v_and_b32 v141, 0xffff0000, v90
    v_fmac_f32 v124, v106, v140
    v_fmac_f32 v125, v106, v141
    v_fmac_f32 v132, v114, v140
    v_fmac_f32 v133, v114, v141
    v_lshlrev_b32 v140, 16, v91
    v_and_b32 v141, 0xffff0000, v91
    v_fmac_f32 v126, v106, v140
    v_fmac_f32 v127, v106, v141
    v_fmac_f32 v134, v114, v140
    v_fmac_f32 v135, v114, v141
    s_waitcnt vmcnt(0)
    v_lshlrev_b32 v140, 16, v92
    v_and_b32 v141, 0xffff0000, v92
    v_fmac_f32 v120, v107, v140
    v_fmac_f32 v121, v107, v141
    v_fmac_f32 v128, v115, v140
    v_fmac_f32 v129, v115, v141
    v_lshlrev_b32 v140, 16, v93
    v_and_b32 v141, 0xffff0000, v93
    v_fmac_f32 v122, v107, v140
    v_fmac_f32 v123, v107, v141
    v_fmac_f32 v130, v115, v140
    v_fmac_f32 v131, v115, v141
    v_lshlrev_b32 v140, 16, v94
    v_and_b32 v141, 0xffff0000, v94
    v_fmac_f32 v124, v107, v140
    v_fmac_f32 v125, v107, v141
    v_fmac_f32 v132, v115, v140
    v_fmac_f32 v133, v115, v141
    v_lshlrev_b32 v140, 16, v95
    v_and_b32 v141, 0xffff0000, v95
    v_fmac_f32 v126, v107, v140
    v_fmac_f32 v127, v107, v141
    v_fmac_f32 v134, v115, v140
    v_fmac_f32 v135, v115, v141
    v_lshrrev_b32 v5, 4, v0
    v_lshlrev_b32 v6, 9, v5
    v_lshl_add_u32 v6, v3, 5, v6
    ds_write_b128 v6, v[120:123]
    ds_write_b128 v6, v[124:127] offset:16
    ds_write_b128 v6, v[128:131] offset:16384
    ds_write_b128 v6, v[132:135] offset:16400
    v_lshlrev_b32 v7, 3, v5
    v_mov_b32 v24, v20
    v_mov_b32 v25, v22
    v_mov_b32 v26, v21
    v_mov_b32 v27, v23
    ds_write_b64 v7, v[24:25] offset:32768
    ds_write_b64 v7, v[26:27] offset:33024
    s_waitcnt lgkmcnt(0)
    s_barrier
    v_cmp_gt_u32 vcc, 256, v0
    s_and_saveexec_b64 s[16:17], vcc
    s_cbranch_execz K2_END
    v_lshrrev_b32 v5, 7, v0
    v_and_b32 v6, 127, v0
    v_lshlrev_b32 v7, 8, v5
    v_lshlrev_b32 v8, 14, v5
    v_lshl_add_u32 v8, v6, 2, v8

    ds_read_b64 v[32:33], v7 offset:32768
    ds_read_b32 v100, v8 offset:0
    ds_read_b64 v[34:35], v7 offset:32776
    ds_read_b32 v101, v8 offset:512
    ds_read_b64 v[36:37], v7 offset:32784
    ds_read_b32 v102, v8 offset:1024
    ds_read_b64 v[38:39], v7 offset:32792
    ds_read_b32 v103, v8 offset:1536
    ds_read_b64 v[40:41], v7 offset:32800
    ds_read_b32 v104, v8 offset:2048
    ds_read_b64 v[42:43], v7 offset:32808
    ds_read_b32 v105, v8 offset:2560
    ds_read_b64 v[44:45], v7 offset:32816
    ds_read_b32 v106, v8 offset:3072
    ds_read_b64 v[46:47], v7 offset:32824
    ds_read_b32 v107, v8 offset:3584
    ds_read_b64 v[48:49], v7 offset:32832
    ds_read_b32 v108, v8 offset:4096
    ds_read_b64 v[50:51], v7 offset:32840
    ds_read_b32 v109, v8 offset:4608
    ds_read_b64 v[52:53], v7 offset:32848
    ds_read_b32 v110, v8 offset:5120
    ds_read_b64 v[54:55], v7 offset:32856
    ds_read_b32 v111, v8 offset:5632
    ds_read_b64 v[56:57], v7 offset:32864
    ds_read_b32 v112, v8 offset:6144
    ds_read_b64 v[58:59], v7 offset:32872
    ds_read_b32 v113, v8 offset:6656
    ds_read_b64 v[60:61], v7 offset:32880
    ds_read_b32 v114, v8 offset:7168
    ds_read_b64 v[62:63], v7 offset:32888
    ds_read_b32 v115, v8 offset:7680
    ds_read_b64 v[64:65], v7 offset:32896
    ds_read_b32 v116, v8 offset:8192
    ds_read_b64 v[66:67], v7 offset:32904
    ds_read_b32 v117, v8 offset:8704
    ds_read_b64 v[68:69], v7 offset:32912
    ds_read_b32 v118, v8 offset:9216
    ds_read_b64 v[70:71], v7 offset:32920
    ds_read_b32 v119, v8 offset:9728
    ds_read_b64 v[72:73], v7 offset:32928
    ds_read_b32 v120, v8 offset:10240
    ds_read_b64 v[74:75], v7 offset:32936
    ds_read_b32 v121, v8 offset:10752
    ds_read_b64 v[76:77], v7 offset:32944
    ds_read_b32 v122, v8 offset:11264
    ds_read_b64 v[78:79], v7 offset:32952
    ds_read_b32 v123, v8 offset:11776
    ds_read_b64 v[80:81], v7 offset:32960
    ds_read_b32 v124, v8 offset:12288
    ds_read_b64 v[82:83], v7 offset:32968
    ds_read_b32 v125, v8 offset:12800
    ds_read_b64 v[84:85], v7 offset:32976
    ds_read_b32 v126, v8 offset:13312
    ds_read_b64 v[86:87], v7 offset:32984
    ds_read_b32 v127, v8 offset:13824
    ds_read_b64 v[88:89], v7 offset:32992
    ds_read_b32 v128, v8 offset:14336
    ds_read_b64 v[90:91], v7 offset:33000
    ds_read_b32 v129, v8 offset:14848
    ds_read_b64 v[92:93], v7 offset:33008
    ds_read_b32 v130, v8 offset:15360
    ds_read_b64 v[94:95], v7 offset:33016
    ds_read_b32 v131, v8 offset:15872
    s_waitcnt lgkmcnt(0)
    v_max_f32 v20, v32, v34
    v_max_f32 v20, v20, v36
    v_max_f32 v20, v20, v38
    v_max_f32 v20, v20, v40
    v_max_f32 v20, v20, v42
    v_max_f32 v20, v20, v44
    v_max_f32 v20, v20, v46
    v_max_f32 v20, v20, v48
    v_max_f32 v20, v20, v50
    v_max_f32 v20, v20, v52
    v_max_f32 v20, v20, v54
    v_max_f32 v20, v20, v56
    v_max_f32 v20, v20, v58
    v_max_f32 v20, v20, v60
    v_max_f32 v20, v20, v62
    v_max_f32 v20, v20, v64
    v_max_f32 v20, v20, v66
    v_max_f32 v20, v20, v68
    v_max_f32 v20, v20, v70
    v_max_f32 v20, v20, v72
    v_max_f32 v20, v20, v74
    v_max_f32 v20, v20, v76
    v_max_f32 v20, v20, v78
    v_max_f32 v20, v20, v80
    v_max_f32 v20, v20, v82
    v_max_f32 v20, v20, v84
    v_max_f32 v20, v20, v86
    v_max_f32 v20, v20, v88
    v_max_f32 v20, v20, v90
    v_max_f32 v20, v20, v92
    v_max_f32 v20, v20, v94
    v_sub_f32 v32, v32, v20
    v_mul_f32 v32, 0x3fb8aa3b, v32
    v_exp_f32 v32, v32
    v_sub_f32 v34, v34, v20
    v_mul_f32 v34, 0x3fb8aa3b, v34
    v_exp_f32 v34, v34
    v_sub_f32 v36, v36, v20
    v_mul_f32 v36, 0x3fb8aa3b, v36
    v_exp_f32 v36, v36
    v_sub_f32 v38, v38, v20
    v_mul_f32 v38, 0x3fb8aa3b, v38
    v_exp_f32 v38, v38
    v_sub_f32 v40, v40, v20
    v_mul_f32 v40, 0x3fb8aa3b, v40
    v_exp_f32 v40, v40
    v_sub_f32 v42, v42, v20
    v_mul_f32 v42, 0x3fb8aa3b, v42
    v_exp_f32 v42, v42
    v_sub_f32 v44, v44, v20
    v_mul_f32 v44, 0x3fb8aa3b, v44
    v_exp_f32 v44, v44
    v_sub_f32 v46, v46, v20
    v_mul_f32 v46, 0x3fb8aa3b, v46
    v_exp_f32 v46, v46
    v_sub_f32 v48, v48, v20
    v_mul_f32 v48, 0x3fb8aa3b, v48
    v_exp_f32 v48, v48
    v_sub_f32 v50, v50, v20
    v_mul_f32 v50, 0x3fb8aa3b, v50
    v_exp_f32 v50, v50
    v_sub_f32 v52, v52, v20
    v_mul_f32 v52, 0x3fb8aa3b, v52
    v_exp_f32 v52, v52
    v_sub_f32 v54, v54, v20
    v_mul_f32 v54, 0x3fb8aa3b, v54
    v_exp_f32 v54, v54
    v_sub_f32 v56, v56, v20
    v_mul_f32 v56, 0x3fb8aa3b, v56
    v_exp_f32 v56, v56
    v_sub_f32 v58, v58, v20
    v_mul_f32 v58, 0x3fb8aa3b, v58
    v_exp_f32 v58, v58
    v_sub_f32 v60, v60, v20
    v_mul_f32 v60, 0x3fb8aa3b, v60
    v_exp_f32 v60, v60
    v_sub_f32 v62, v62, v20
    v_mul_f32 v62, 0x3fb8aa3b, v62
    v_exp_f32 v62, v62
    v_sub_f32 v64, v64, v20
    v_mul_f32 v64, 0x3fb8aa3b, v64
    v_exp_f32 v64, v64
    v_sub_f32 v66, v66, v20
    v_mul_f32 v66, 0x3fb8aa3b, v66
    v_exp_f32 v66, v66
    v_sub_f32 v68, v68, v20
    v_mul_f32 v68, 0x3fb8aa3b, v68
    v_exp_f32 v68, v68
    v_sub_f32 v70, v70, v20
    v_mul_f32 v70, 0x3fb8aa3b, v70
    v_exp_f32 v70, v70
    v_sub_f32 v72, v72, v20
    v_mul_f32 v72, 0x3fb8aa3b, v72
    v_exp_f32 v72, v72
    v_sub_f32 v74, v74, v20
    v_mul_f32 v74, 0x3fb8aa3b, v74
    v_exp_f32 v74, v74
    v_sub_f32 v76, v76, v20
    v_mul_f32 v76, 0x3fb8aa3b, v76
    v_exp_f32 v76, v76
    v_sub_f32 v78, v78, v20
    v_mul_f32 v78, 0x3fb8aa3b, v78
    v_exp_f32 v78, v78
    v_sub_f32 v80, v80, v20
    v_mul_f32 v80, 0x3fb8aa3b, v80
    v_exp_f32 v80, v80
    v_sub_f32 v82, v82, v20
    v_mul_f32 v82, 0x3fb8aa3b, v82
    v_exp_f32 v82, v82
    v_sub_f32 v84, v84, v20
    v_mul_f32 v84, 0x3fb8aa3b, v84
    v_exp_f32 v84, v84
    v_sub_f32 v86, v86, v20
    v_mul_f32 v86, 0x3fb8aa3b, v86
    v_exp_f32 v86, v86
    v_sub_f32 v88, v88, v20
    v_mul_f32 v88, 0x3fb8aa3b, v88
    v_exp_f32 v88, v88
    v_sub_f32 v90, v90, v20
    v_mul_f32 v90, 0x3fb8aa3b, v90
    v_exp_f32 v90, v90
    v_sub_f32 v92, v92, v20
    v_mul_f32 v92, 0x3fb8aa3b, v92
    v_exp_f32 v92, v92
    v_sub_f32 v94, v94, v20
    v_mul_f32 v94, 0x3fb8aa3b, v94
    v_exp_f32 v94, v94
    s_nop 0
    v_mul_f32 v21, v32, v33
    v_mul_f32 v22, v32, v100
    v_fmac_f32 v21, v34, v35
    v_fmac_f32 v22, v34, v101
    v_fmac_f32 v21, v36, v37
    v_fmac_f32 v22, v36, v102
    v_fmac_f32 v21, v38, v39
    v_fmac_f32 v22, v38, v103
    v_fmac_f32 v21, v40, v41
    v_fmac_f32 v22, v40, v104
    v_fmac_f32 v21, v42, v43
    v_fmac_f32 v22, v42, v105
    v_fmac_f32 v21, v44, v45
    v_fmac_f32 v22, v44, v106
    v_fmac_f32 v21, v46, v47
    v_fmac_f32 v22, v46, v107
    v_fmac_f32 v21, v48, v49
    v_fmac_f32 v22, v48, v108
    v_fmac_f32 v21, v50, v51
    v_fmac_f32 v22, v50, v109
    v_fmac_f32 v21, v52, v53
    v_fmac_f32 v22, v52, v110
    v_fmac_f32 v21, v54, v55
    v_fmac_f32 v22, v54, v111
    v_fmac_f32 v21, v56, v57
    v_fmac_f32 v22, v56, v112
    v_fmac_f32 v21, v58, v59
    v_fmac_f32 v22, v58, v113
    v_fmac_f32 v21, v60, v61
    v_fmac_f32 v22, v60, v114
    v_fmac_f32 v21, v62, v63
    v_fmac_f32 v22, v62, v115
    v_fmac_f32 v21, v64, v65
    v_fmac_f32 v22, v64, v116
    v_fmac_f32 v21, v66, v67
    v_fmac_f32 v22, v66, v117
    v_fmac_f32 v21, v68, v69
    v_fmac_f32 v22, v68, v118
    v_fmac_f32 v21, v70, v71
    v_fmac_f32 v22, v70, v119
    v_fmac_f32 v21, v72, v73
    v_fmac_f32 v22, v72, v120
    v_fmac_f32 v21, v74, v75
    v_fmac_f32 v22, v74, v121
    v_fmac_f32 v21, v76, v77
    v_fmac_f32 v22, v76, v122
    v_fmac_f32 v21, v78, v79
    v_fmac_f32 v22, v78, v123
    v_fmac_f32 v21, v80, v81
    v_fmac_f32 v22, v80, v124
    v_fmac_f32 v21, v82, v83
    v_fmac_f32 v22, v82, v125
    v_fmac_f32 v21, v84, v85
    v_fmac_f32 v22, v84, v126
    v_fmac_f32 v21, v86, v87
    v_fmac_f32 v22, v86, v127
    v_fmac_f32 v21, v88, v89
    v_fmac_f32 v22, v88, v128
    v_fmac_f32 v21, v90, v91
    v_fmac_f32 v22, v90, v129
    v_fmac_f32 v21, v92, v93
    v_fmac_f32 v22, v92, v130
    v_fmac_f32 v21, v94, v95
    v_fmac_f32 v22, v94, v131
    s_lshl_b32 s14, s10, 1
    v_add_u32 v9, s14, v5
    v_lshl_add_u32 v9, v9, 4, s11
    v_lshlrev_b32 v10, 9, v9
    v_lshl_add_u32 v10, v6, 2, v10
    v_add_u32 v10, 65536, v10
    global_store_dword v10, v22, s[8:9]
    v_lshlrev_b32 v11, 3, v9
    v_add_u32 v11, 327680, v11
    v_cmp_eq_u32 vcc, 0, v6
    s_and_saveexec_b64 s[16:17], vcc
    global_store_dwordx2 v11, v[20:21], s[8:9]

K2_END:
    s_endpgm
.p2align 8
.globl k3_wo_kernel
.type k3_wo_kernel,@function
k3_wo_kernel:
    s_cmp_ge_u32 s2, 256
    s_cbranch_scc1 K3_END
    s_load_dwordx2 s[4:5], s[0:1], 32
    s_load_dwordx2 s[8:9], s[0:1], 96
    v_mul_u32_u24 v1, 911, v0
    v_lshrrev_b32 v1, 16, v1
    v_mul_u32_u24 v2, 72, v1
    v_sub_u32 v2, v0, v2
    s_mul_i32 s10, s2, 18432
    v_lshlrev_b32 v3, 4, v0
    v_add_u32 v3, s10, v3
    s_lshr_b32 s11, s2, 3
    s_and_b32 s12, s2, 7
    s_and_b32 s20, s2, 15
    s_waitcnt lgkmcnt(0)
    global_load_dwordx4 v[32:35], v3, s[4:5] nt
    v_add_u32 v3, 9216, v3
    global_load_dwordx4 v[36:39], v3, s[4:5] nt

    v_and_b32 v4, 15, v0
    v_bfe_u32 v5, v0, 4, 2
    s_lshl_b32 s13, s11, 13
    s_lshl_b32 s14, s12, 6
    s_add_u32 s13, s13, s14
    s_add_u32 s13, s13, 65536
    v_lshlrev_b32 v6, 11, v5
    v_lshl_add_u32 v6, v4, 2, v6
    v_add_u32 v6, s13, v6
    s_lshl_b32 s15, s11, 7
    s_add_u32 s15, s15, 327680
    v_lshlrev_b32 v7, 5, v5
    v_add_u32 v7, s15, v7

    global_load_dword v60, v6, s[8:9] offset:0
    global_load_dword v61, v6, s[8:9] offset:512
    global_load_dword v62, v6, s[8:9] offset:1024
    global_load_dword v63, v6, s[8:9] offset:1536
    global_load_dwordx4 v[64:67], v7, s[8:9]
    global_load_dwordx4 v[68:71], v7, s[8:9] offset:16
    v_and_b32 v8, 63, v0
    v_xor_b32 v9, 16, v8
    v_lshlrev_b32 v9, 2, v9
    v_xor_b32 v15, 32, v8
    v_lshlrev_b32 v15, 2, v15
    s_waitcnt vmcnt(0)
    v_max_f32 v72, v64, v66
    v_max3_f32 v72, v72, v68, v70
    ds_bpermute_b32 v73, v9, v72
    s_waitcnt lgkmcnt(0)
    v_max_f32 v72, v72, v73
    ds_bpermute_b32 v73, v15, v72
    s_waitcnt lgkmcnt(0)
    v_max_f32 v72, v72, v73

    v_sub_f32 v64, v64, v72
    v_mul_f32 v64, 0x3fb8aa3b, v64
    v_exp_f32 v64, v64
    v_sub_f32 v66, v66, v72
    v_mul_f32 v66, 0x3fb8aa3b, v66
    v_exp_f32 v66, v66
    v_sub_f32 v68, v68, v72
    v_mul_f32 v68, 0x3fb8aa3b, v68
    v_exp_f32 v68, v68
    v_sub_f32 v70, v70, v72
    v_mul_f32 v70, 0x3fb8aa3b, v70
    v_exp_f32 v70, v70
    s_nop 0
    v_mul_f32 v74, v64, v65
    v_mul_f32 v75, v64, v60
    v_fmac_f32 v74, v66, v67
    v_fmac_f32 v75, v66, v61
    v_fmac_f32 v74, v68, v69
    v_fmac_f32 v75, v68, v62
    v_fmac_f32 v74, v70, v71
    v_fmac_f32 v75, v70, v63
    ds_bpermute_b32 v76, v9, v74
    ds_bpermute_b32 v77, v9, v75
    s_waitcnt lgkmcnt(0)
    v_add_f32 v74, v74, v76
    v_add_f32 v75, v75, v77
    ds_bpermute_b32 v76, v15, v74
    ds_bpermute_b32 v77, v15, v75
    s_waitcnt lgkmcnt(0)
    v_add_f32 v74, v74, v76
    v_add_f32 v75, v75, v77
    v_rcp_f32 v76, v74
    s_nop 0
    v_fma_f32 v77, -v74, v76, 1.0
    v_fmac_f32 v76, v77, v76
    v_mul_f32 v75, v75, v76

    v_cvt_pk_bf16_f32 v75, v75, v75
    v_lshlrev_b32 v75, 16, v75
    v_lshlrev_b32 v16, 2, v4
    ds_write_b32 v16, v75
    s_waitcnt lgkmcnt(0)
    s_barrier

    v_lshlrev_b32 v10, 2, v1
    ds_read_b32 v11, v10 offset:0
    ds_read_b32 v12, v10 offset:32
    s_waitcnt vmcnt(0) lgkmcnt(0)
    v_lshlrev_b32 v50, 16, v32
    v_and_b32 v51, 0xffff0000, v32
    v_mul_f32 v40, v11, v50
    v_mul_f32 v41, v11, v51
    v_lshlrev_b32 v50, 16, v33
    v_and_b32 v51, 0xffff0000, v33
    v_mul_f32 v42, v11, v50
    v_mul_f32 v43, v11, v51
    v_lshlrev_b32 v50, 16, v34
    v_and_b32 v51, 0xffff0000, v34
    v_mul_f32 v44, v11, v50
    v_mul_f32 v45, v11, v51
    v_lshlrev_b32 v50, 16, v35
    v_and_b32 v51, 0xffff0000, v35
    v_mul_f32 v46, v11, v50
    v_mul_f32 v47, v11, v51
    v_lshlrev_b32 v50, 16, v36
    v_and_b32 v51, 0xffff0000, v36
    v_fmac_f32 v40, v12, v50
    v_fmac_f32 v41, v12, v51
    v_lshlrev_b32 v50, 16, v37
    v_and_b32 v51, 0xffff0000, v37
    v_fmac_f32 v42, v12, v50
    v_fmac_f32 v43, v12, v51
    v_lshlrev_b32 v50, 16, v38
    v_and_b32 v51, 0xffff0000, v38
    v_fmac_f32 v44, v12, v50
    v_fmac_f32 v45, v12, v51
    v_lshlrev_b32 v50, 16, v39
    v_and_b32 v51, 0xffff0000, v39
    v_fmac_f32 v46, v12, v50
    v_fmac_f32 v47, v12, v51
    v_mul_u32_u24 v13, 2304, v1
    v_lshl_add_u32 v13, v2, 5, v13
    ds_write_b128 v13, v[40:43] offset:64
    ds_write_b128 v13, v[44:47] offset:80
    s_waitcnt lgkmcnt(0)
    s_barrier
    v_lshlrev_b32 v14, 2, v0

    ds_read_b32 v40, v14 offset:64
    ds_read_b32 v41, v14 offset:2368
    ds_read_b32 v42, v14 offset:4672
    ds_read_b32 v43, v14 offset:6976
    ds_read_b32 v44, v14 offset:9280
    ds_read_b32 v45, v14 offset:11584
    ds_read_b32 v46, v14 offset:13888
    ds_read_b32 v47, v14 offset:16192
    s_waitcnt lgkmcnt(0)
    v_add_f32 v40, v40, v41
    v_add_f32 v40, v40, v42
    v_add_f32 v40, v40, v43
    v_add_f32 v40, v40, v44
    v_add_f32 v40, v40, v45
    v_add_f32 v40, v40, v46
    v_add_f32 v40, v40, v47
    s_mul_i32 s21, s20, 2304
    s_add_u32 s21, s21, 331776
    v_add_u32 v14, s21, v14
    global_atomic_add_f32 v14, v40, s[8:9]

K3_END:
    s_endpgm
.p2align 8
.globl k4_mlp_kernel
.type k4_mlp_kernel,@function
k4_mlp_kernel:
    s_cmp_ge_u32 s2, 144
    s_cbranch_scc1 K4_END
    s_load_dwordx2 s[4:5], s[0:1], 0
    s_load_dwordx2 s[6:7], s[0:1], 48
    s_load_dwordx2 s[8:9], s[0:1], 96
    s_load_dwordx2 s[22:23], s[0:1], 56
    s_load_dwordx2 s[24:25], s[0:1], 64
    s_load_dwordx2 s[34:35], s[0:1], 72
    s_load_dwordx2 s[36:37], s[0:1], 80
    v_mul_u32_u24 v1, 911, v0
    v_lshrrev_b32 v1, 16, v1
    v_mul_u32_u24 v2, 72, v1
    v_sub_u32 v2, v0, v2
    s_and_b32 s20, s2, 15
    s_lshl_b32 s10, s2, 6
    v_lshrrev_b32 v3, 2, v0
    v_and_b32 v4, 3, v0
    v_mul_u32_u24 v5, 9216, v3
    v_lshl_add_u32 v5, v4, 4, v5
    v_add_u32 v5, s10, v5
    s_mul_i32 s11, s2, 36864
    v_lshlrev_b32 v6, 4, v0
    v_add_u32 v6, s11, v6
    s_waitcnt lgkmcnt(0)

    v_lshlrev_b32 v14, 2, v0
    v_add_u32 v15, 331776, v14
    global_load_dword v61, v15, s[8:9] offset:0
    v_add_u32 v15, 2304, v15
    global_load_dword v62, v15, s[8:9] offset:0
    v_add_u32 v15, 2304, v15
    global_load_dword v63, v15, s[8:9] offset:0
    v_add_u32 v15, 2304, v15
    global_load_dword v64, v15, s[8:9] offset:0
    v_add_u32 v15, 2304, v15
    global_load_dword v65, v15, s[8:9] offset:0
    v_add_u32 v15, 2304, v15
    global_load_dword v66, v15, s[8:9] offset:0
    v_add_u32 v15, 2304, v15
    global_load_dword v67, v15, s[8:9] offset:0
    v_add_u32 v15, 2304, v15
    global_load_dword v68, v15, s[8:9] offset:0
    v_add_u32 v15, 2304, v15
    global_load_dword v69, v15, s[8:9] offset:0
    v_add_u32 v15, 2304, v15
    global_load_dword v70, v15, s[8:9] offset:0
    v_add_u32 v15, 2304, v15
    global_load_dword v71, v15, s[8:9] offset:0
    v_add_u32 v15, 2304, v15
    global_load_dword v72, v15, s[8:9] offset:0
    v_add_u32 v15, 2304, v15
    global_load_dword v73, v15, s[8:9] offset:0
    v_add_u32 v15, 2304, v15
    global_load_dword v74, v15, s[8:9] offset:0
    v_add_u32 v15, 2304, v15
    global_load_dword v75, v15, s[8:9] offset:0
    v_add_u32 v15, 2304, v15
    global_load_dword v76, v15, s[8:9] offset:0
    v_lshlrev_b32 v16, 1, v0
    global_load_ushort v77, v16, s[4:5]
    global_load_dwordx4 v[100:103], v5, s[6:7] nt
    v_add_u32 v5, 1327104, v5
    global_load_dwordx4 v[104:107], v5, s[6:7] nt
    v_add_u32 v5, 1327104, v5
    global_load_dwordx4 v[108:111], v5, s[6:7] nt
    v_add_u32 v5, 1327104, v5
    global_load_dwordx4 v[112:115], v5, s[6:7] nt
    global_load_dwordx4 v[132:135], v6, s[24:25] nt
    v_add_u32 v6, 9216, v6
    global_load_dwordx4 v[136:139], v6, s[24:25] nt
    v_add_u32 v6, 9216, v6
    global_load_dwordx4 v[140:143], v6, s[24:25] nt
    v_add_u32 v6, 9216, v6
    global_load_dwordx4 v[144:147], v6, s[24:25] nt
    v_and_b32 v26, 31, v0
    v_lshlrev_b32 v26, 1, v26
    v_add_u32 v26, s10, v26
    global_load_ushort v99, v26, s[22:23]

    s_waitcnt vmcnt(9)
    v_add_f32 v61, v61, v62
    v_add_f32 v61, v61, v63
    v_add_f32 v61, v61, v64
    v_add_f32 v61, v61, v65
    v_add_f32 v61, v61, v66
    v_add_f32 v61, v61, v67
    v_add_f32 v61, v61, v68
    v_add_f32 v61, v61, v69
    v_add_f32 v61, v61, v70
    v_add_f32 v61, v61, v71
    v_add_f32 v61, v61, v72
    v_add_f32 v61, v61, v73
    v_add_f32 v61, v61, v74
    v_add_f32 v61, v61, v75
    v_add_f32 v61, v61, v76
    v_cvt_pk_bf16_f32 v61, v61, v61
    v_lshlrev_b32 v61, 16, v61
    v_lshlrev_b32 v77, 16, v77
    v_add_f32 v60, v61, v77
    v_cvt_pk_bf16_f32 v60, v60, v60
    v_lshlrev_b32 v60, 16, v60
    v_mov_b32 v59, v60
    ds_write_b32 v14, v60
    s_waitcnt lgkmcnt(0)
    s_barrier
    v_and_b32 v17, 63, v0
    v_lshlrev_b32 v17, 2, v17

    ds_read_b32 v60, v17 offset:0
    ds_read_b32 v61, v17 offset:256
    ds_read_b32 v62, v17 offset:512
    ds_read_b32 v63, v17 offset:768
    ds_read_b32 v64, v17 offset:1024
    ds_read_b32 v65, v17 offset:1280
    ds_read_b32 v66, v17 offset:1536
    ds_read_b32 v67, v17 offset:1792
    ds_read_b32 v68, v17 offset:2048
    s_waitcnt lgkmcnt(0)
    v_add_f32 v70, v60, v61
    v_add_f32 v70, v70, v62
    v_add_f32 v70, v70, v63
    v_add_f32 v70, v70, v64
    v_add_f32 v70, v70, v65
    v_add_f32 v70, v70, v66
    v_add_f32 v70, v70, v67
    v_add_f32 v70, v70, v68
    s_nop 1
    v_add_f32_dpp v70, v70, v70 row_ror:8 row_mask:0xf bank_mask:0xf
    s_nop 1
    v_add_f32_dpp v70, v70, v70 row_ror:4 row_mask:0xf bank_mask:0xf
    s_nop 1
    v_add_f32_dpp v70, v70, v70 row_ror:2 row_mask:0xf bank_mask:0xf
    s_nop 1
    v_add_f32_dpp v70, v70, v70 row_ror:1 row_mask:0xf bank_mask:0xf
    s_nop 1
    v_readlane_b32 s26, v70, 0
    v_readlane_b32 s27, v70, 16
    v_readlane_b32 s28, v70, 32
    v_readlane_b32 s29, v70, 48
    s_nop 1
    v_mov_b32 v70, s26
    v_add_f32 v70, s27, v70
    v_add_f32 v70, s28, v70
    v_add_f32 v70, s29, v70
    v_mul_f32 v70, 0x3ae38e39, v70
    v_sub_f32 v72, v60, v70
    v_mul_f32 v71, v72, v72
    v_sub_f32 v72, v61, v70
    v_fmac_f32 v71, v72, v72
    v_sub_f32 v72, v62, v70
    v_fmac_f32 v71, v72, v72
    v_sub_f32 v72, v63, v70
    v_fmac_f32 v71, v72, v72
    v_sub_f32 v72, v64, v70
    v_fmac_f32 v71, v72, v72
    v_sub_f32 v72, v65, v70
    v_fmac_f32 v71, v72, v72
    v_sub_f32 v72, v66, v70
    v_fmac_f32 v71, v72, v72
    v_sub_f32 v72, v67, v70
    v_fmac_f32 v71, v72, v72
    v_sub_f32 v72, v68, v70
    v_fmac_f32 v71, v72, v72
    s_nop 1
    v_add_f32_dpp v71, v71, v71 row_ror:8 row_mask:0xf bank_mask:0xf
    s_nop 1
    v_add_f32_dpp v71, v71, v71 row_ror:4 row_mask:0xf bank_mask:0xf
    s_nop 1
    v_add_f32_dpp v71, v71, v71 row_ror:2 row_mask:0xf bank_mask:0xf
    s_nop 1
    v_add_f32_dpp v71, v71, v71 row_ror:1 row_mask:0xf bank_mask:0xf
    s_nop 1
    v_readlane_b32 s26, v71, 0
    v_readlane_b32 s27, v71, 16
    v_readlane_b32 s28, v71, 32
    v_readlane_b32 s29, v71, 48
    s_nop 1
    v_mov_b32 v71, s26
    v_add_f32 v71, s27, v71
    v_add_f32 v71, s28, v71
    v_add_f32 v71, s29, v71
    v_mul_f32 v71, 0x3ae38e39, v71
    v_cvt_pk_bf16_f32 v70, v70, v70
    v_cvt_pk_bf16_f32 v71, v71, v71
    v_lshlrev_b32 v70, 16, v70
    v_lshlrev_b32 v71, 16, v71
    v_add_f32 v71, 0x3727c5ac, v71
    v_cvt_pk_bf16_f32 v71, v71, v71
    v_lshlrev_b32 v71, 16, v71
    v_sqrt_f32 v71, v71
    s_nop 0
    v_cvt_pk_bf16_f32 v71, v71, v71
    v_lshlrev_b32 v71, 16, v71
    v_rcp_f32 v72, v71
    s_nop 0
    v_fma_f32 v73, -v71, v72, 1.0
    v_fmac_f32 v72, v73, v72
    v_sub_f32 v60, v60, v70
    v_sub_f32 v61, v61, v70
    v_sub_f32 v62, v62, v70
    v_sub_f32 v63, v63, v70
    v_sub_f32 v64, v64, v70
    v_sub_f32 v65, v65, v70
    v_sub_f32 v66, v66, v70
    v_sub_f32 v67, v67, v70
    v_sub_f32 v68, v68, v70
    v_cvt_pk_bf16_f32 v60, v60, v60
    v_cvt_pk_bf16_f32 v61, v61, v61
    v_cvt_pk_bf16_f32 v62, v62, v62
    v_cvt_pk_bf16_f32 v63, v63, v63
    v_cvt_pk_bf16_f32 v64, v64, v64
    v_cvt_pk_bf16_f32 v65, v65, v65
    v_cvt_pk_bf16_f32 v66, v66, v66
    v_cvt_pk_bf16_f32 v67, v67, v67
    v_cvt_pk_bf16_f32 v68, v68, v68
    v_lshlrev_b32 v60, 16, v60
    v_lshlrev_b32 v61, 16, v61
    v_lshlrev_b32 v62, 16, v62
    v_lshlrev_b32 v63, 16, v63
    v_lshlrev_b32 v64, 16, v64
    v_lshlrev_b32 v65, 16, v65
    v_lshlrev_b32 v66, 16, v66
    v_lshlrev_b32 v67, 16, v67
    v_lshlrev_b32 v68, 16, v68
    v_mul_f32 v73, v60, v72
    v_fma_f32 v60, -v71, v73, v60
    v_fma_f32 v60, v60, v72, v73
    v_mul_f32 v73, v61, v72
    v_fma_f32 v61, -v71, v73, v61
    v_fma_f32 v61, v61, v72, v73
    v_mul_f32 v73, v62, v72
    v_fma_f32 v62, -v71, v73, v62
    v_fma_f32 v62, v62, v72, v73
    v_mul_f32 v73, v63, v72
    v_fma_f32 v63, -v71, v73, v63
    v_fma_f32 v63, v63, v72, v73
    v_mul_f32 v73, v64, v72
    v_fma_f32 v64, -v71, v73, v64
    v_fma_f32 v64, v64, v72, v73
    v_mul_f32 v73, v65, v72
    v_fma_f32 v65, -v71, v73, v65
    v_fma_f32 v65, v65, v72, v73
    v_mul_f32 v73, v66, v72
    v_fma_f32 v66, -v71, v73, v66
    v_fma_f32 v66, v66, v72, v73
    v_mul_f32 v73, v67, v72
    v_fma_f32 v67, -v71, v73, v67
    v_fma_f32 v67, v67, v72, v73
    v_mul_f32 v73, v68, v72
    v_fma_f32 v68, -v71, v73, v68
    v_fma_f32 v68, v68, v72, v73
    v_cvt_pk_bf16_f32 v60, v60, v60
    v_cvt_pk_bf16_f32 v61, v61, v61
    v_cvt_pk_bf16_f32 v62, v62, v62
    v_cvt_pk_bf16_f32 v63, v63, v63
    v_cvt_pk_bf16_f32 v64, v64, v64
    v_cvt_pk_bf16_f32 v65, v65, v65
    v_cvt_pk_bf16_f32 v66, v66, v66
    v_cvt_pk_bf16_f32 v67, v67, v67
    v_cvt_pk_bf16_f32 v68, v68, v68
    v_lshlrev_b32 v60, 16, v60
    v_lshlrev_b32 v61, 16, v61
    v_lshlrev_b32 v62, 16, v62
    v_lshlrev_b32 v63, 16, v63
    v_lshlrev_b32 v64, 16, v64
    v_lshlrev_b32 v65, 16, v65
    v_lshlrev_b32 v66, 16, v66
    v_lshlrev_b32 v67, 16, v67
    v_lshlrev_b32 v68, 16, v68
    s_barrier
    ds_write_b32 v17, v60 offset:0
    ds_write_b32 v17, v61 offset:256
    ds_write_b32 v17, v62 offset:512
    ds_write_b32 v17, v63 offset:768
    ds_write_b32 v17, v64 offset:1024
    ds_write_b32 v17, v65 offset:1280
    ds_write_b32 v17, v66 offset:1536
    ds_write_b32 v17, v67 offset:1792
    ds_write_b32 v17, v68 offset:2048
    s_waitcnt lgkmcnt(0)
    s_barrier
    v_lshlrev_b32 v18, 2, v3
    ds_read_b32 v60, v18 offset:0
    ds_read_b32 v61, v18 offset:576
    ds_read_b32 v62, v18 offset:1152
    ds_read_b32 v63, v18 offset:1728
    v_mov_b32 v40, 0
    v_mov_b32 v41, 0
    v_mov_b32 v42, 0
    v_mov_b32 v43, 0
    v_mov_b32 v44, 0
    v_mov_b32 v45, 0
    v_mov_b32 v46, 0
    v_mov_b32 v47, 0
    s_waitcnt lgkmcnt(0)
    s_waitcnt vmcnt(7)
    v_lshlrev_b32 v50, 16, v100
    v_and_b32 v51, 0xffff0000, v100
    v_fmac_f32 v40, v60, v50
    v_fmac_f32 v41, v60, v51
    v_lshlrev_b32 v50, 16, v101
    v_and_b32 v51, 0xffff0000, v101
    v_fmac_f32 v42, v60, v50
    v_fmac_f32 v43, v60, v51
    v_lshlrev_b32 v50, 16, v102
    v_and_b32 v51, 0xffff0000, v102
    v_fmac_f32 v44, v60, v50
    v_fmac_f32 v45, v60, v51
    v_lshlrev_b32 v50, 16, v103
    v_and_b32 v51, 0xffff0000, v103
    v_fmac_f32 v46, v60, v50
    v_fmac_f32 v47, v60, v51
    s_waitcnt vmcnt(6)
    v_lshlrev_b32 v50, 16, v104
    v_and_b32 v51, 0xffff0000, v104
    v_fmac_f32 v40, v61, v50
    v_fmac_f32 v41, v61, v51
    v_lshlrev_b32 v50, 16, v105
    v_and_b32 v51, 0xffff0000, v105
    v_fmac_f32 v42, v61, v50
    v_fmac_f32 v43, v61, v51
    v_lshlrev_b32 v50, 16, v106
    v_and_b32 v51, 0xffff0000, v106
    v_fmac_f32 v44, v61, v50
    v_fmac_f32 v45, v61, v51
    v_lshlrev_b32 v50, 16, v107
    v_and_b32 v51, 0xffff0000, v107
    v_fmac_f32 v46, v61, v50
    v_fmac_f32 v47, v61, v51
    s_waitcnt vmcnt(5)
    v_lshlrev_b32 v50, 16, v108
    v_and_b32 v51, 0xffff0000, v108
    v_fmac_f32 v40, v62, v50
    v_fmac_f32 v41, v62, v51
    v_lshlrev_b32 v50, 16, v109
    v_and_b32 v51, 0xffff0000, v109
    v_fmac_f32 v42, v62, v50
    v_fmac_f32 v43, v62, v51
    v_lshlrev_b32 v50, 16, v110
    v_and_b32 v51, 0xffff0000, v110
    v_fmac_f32 v44, v62, v50
    v_fmac_f32 v45, v62, v51
    v_lshlrev_b32 v50, 16, v111
    v_and_b32 v51, 0xffff0000, v111
    v_fmac_f32 v46, v62, v50
    v_fmac_f32 v47, v62, v51
    s_waitcnt vmcnt(4)
    v_lshlrev_b32 v50, 16, v112
    v_and_b32 v51, 0xffff0000, v112
    v_fmac_f32 v40, v63, v50
    v_fmac_f32 v41, v63, v51
    v_lshlrev_b32 v50, 16, v113
    v_and_b32 v51, 0xffff0000, v113
    v_fmac_f32 v42, v63, v50
    v_fmac_f32 v43, v63, v51
    v_lshlrev_b32 v50, 16, v114
    v_and_b32 v51, 0xffff0000, v114
    v_fmac_f32 v44, v63, v50
    v_fmac_f32 v45, v63, v51
    v_lshlrev_b32 v50, 16, v115
    v_and_b32 v51, 0xffff0000, v115
    v_fmac_f32 v46, v63, v50
    v_fmac_f32 v47, v63, v51
    s_nop 1
    v_add_f32_dpp v40, v40, v40 row_ror:8 row_mask:0xf bank_mask:0xf
    v_add_f32_dpp v41, v41, v41 row_ror:8 row_mask:0xf bank_mask:0xf
    v_add_f32_dpp v42, v42, v42 row_ror:8 row_mask:0xf bank_mask:0xf
    v_add_f32_dpp v43, v43, v43 row_ror:8 row_mask:0xf bank_mask:0xf
    v_add_f32_dpp v44, v44, v44 row_ror:8 row_mask:0xf bank_mask:0xf
    v_add_f32_dpp v45, v45, v45 row_ror:8 row_mask:0xf bank_mask:0xf
    v_add_f32_dpp v46, v46, v46 row_ror:8 row_mask:0xf bank_mask:0xf
    v_add_f32_dpp v47, v47, v47 row_ror:8 row_mask:0xf bank_mask:0xf
    s_nop 1
    v_add_f32_dpp v40, v40, v40 row_ror:4 row_mask:0xf bank_mask:0xf
    v_add_f32_dpp v41, v41, v41 row_ror:4 row_mask:0xf bank_mask:0xf
    v_add_f32_dpp v42, v42, v42 row_ror:4 row_mask:0xf bank_mask:0xf
    v_add_f32_dpp v43, v43, v43 row_ror:4 row_mask:0xf bank_mask:0xf
    v_add_f32_dpp v44, v44, v44 row_ror:4 row_mask:0xf bank_mask:0xf
    v_add_f32_dpp v45, v45, v45 row_ror:4 row_mask:0xf bank_mask:0xf
    v_add_f32_dpp v46, v46, v46 row_ror:4 row_mask:0xf bank_mask:0xf
    v_add_f32_dpp v47, v47, v47 row_ror:4 row_mask:0xf bank_mask:0xf
    v_and_b32 v21, 63, v0
    v_xor_b32 v22, 16, v21
    v_lshlrev_b32 v22, 2, v22
    v_xor_b32 v23, 32, v21
    v_lshlrev_b32 v23, 2, v23

    ds_bpermute_b32 v50, v22, v40
    ds_bpermute_b32 v51, v22, v41
    ds_bpermute_b32 v52, v22, v42
    ds_bpermute_b32 v53, v22, v43
    ds_bpermute_b32 v54, v22, v44
    ds_bpermute_b32 v55, v22, v45
    ds_bpermute_b32 v56, v22, v46
    ds_bpermute_b32 v57, v22, v47
    s_waitcnt lgkmcnt(0)
    v_add_f32 v40, v40, v50
    v_add_f32 v41, v41, v51
    v_add_f32 v42, v42, v52
    v_add_f32 v43, v43, v53
    v_add_f32 v44, v44, v54
    v_add_f32 v45, v45, v55
    v_add_f32 v46, v46, v56
    v_add_f32 v47, v47, v57
    ds_bpermute_b32 v50, v23, v40
    ds_bpermute_b32 v51, v23, v41
    ds_bpermute_b32 v52, v23, v42
    ds_bpermute_b32 v53, v23, v43
    ds_bpermute_b32 v54, v23, v44
    ds_bpermute_b32 v55, v23, v45
    ds_bpermute_b32 v56, v23, v46
    ds_bpermute_b32 v57, v23, v47
    s_waitcnt lgkmcnt(0)
    v_add_f32 v40, v40, v50
    v_add_f32 v41, v41, v51
    v_add_f32 v42, v42, v52
    v_add_f32 v43, v43, v53
    v_add_f32 v44, v44, v54
    v_add_f32 v45, v45, v55
    v_add_f32 v46, v46, v56
    v_add_f32 v47, v47, v57
    v_lshrrev_b32 v24, 6, v0
    v_lshlrev_b32 v24, 8, v24
    v_lshl_add_u32 v24, v4, 5, v24
    v_cmp_gt_u32 vcc, 4, v21
    s_and_saveexec_b64 s[16:17], vcc
    ds_write_b128 v24, v[40:43] offset:2304
    ds_write_b128 v24, v[44:47] offset:2320
    s_mov_b64 exec, s[16:17]
    s_waitcnt lgkmcnt(0)
    s_barrier
    v_cmp_gt_u32 vcc, 32, v0
    s_and_saveexec_b64 s[16:17], vcc
    v_lshlrev_b32 v25, 2, v0

    ds_read_b32 v40, v25 offset:2304
    ds_read_b32 v41, v25 offset:2560
    ds_read_b32 v42, v25 offset:2816
    ds_read_b32 v43, v25 offset:3072
    ds_read_b32 v44, v25 offset:3328
    ds_read_b32 v45, v25 offset:3584
    ds_read_b32 v46, v25 offset:3840
    ds_read_b32 v47, v25 offset:4096
    ds_read_b32 v48, v25 offset:4352
    s_waitcnt lgkmcnt(0)
    v_add_f32 v40, v40, v41
    v_add_f32 v40, v40, v42
    v_add_f32 v40, v40, v43
    v_add_f32 v40, v40, v44
    v_add_f32 v40, v40, v45
    v_add_f32 v40, v40, v46
    v_add_f32 v40, v40, v47
    v_add_f32 v40, v40, v48
    v_cvt_pk_bf16_f32 v40, v40, v40
    v_lshlrev_b32 v40, 16, v40
    v_lshlrev_b32 v99, 16, v99
    v_add_f32 v40, v40, v99
    v_cvt_pk_bf16_f32 v40, v40, v40
    v_lshlrev_b32 v40, 16, v40
    v_max_f32 v40, 0, v40
    v_mul_f32 v40, v40, v40
    v_cvt_pk_bf16_f32 v40, v40, v40
    v_lshlrev_b32 v40, 16, v40
    ds_write_b32 v25, v40 offset:4608
    s_mov_b64 exec, s[16:17]
    s_waitcnt lgkmcnt(0)
    s_barrier
    v_lshlrev_b32 v10, 2, v1

    ds_read_b32 v60, v10 offset:4608
    ds_read_b32 v61, v10 offset:4640
    ds_read_b32 v62, v10 offset:4672
    ds_read_b32 v63, v10 offset:4704
    v_mov_b32 v40, 0
    v_mov_b32 v41, 0
    v_mov_b32 v42, 0
    v_mov_b32 v43, 0
    v_mov_b32 v44, 0
    v_mov_b32 v45, 0
    v_mov_b32 v46, 0
    v_mov_b32 v47, 0
    s_waitcnt vmcnt(0) lgkmcnt(0)
    v_lshlrev_b32 v50, 16, v132
    v_and_b32 v51, 0xffff0000, v132
    v_fmac_f32 v40, v60, v50
    v_fmac_f32 v41, v60, v51
    v_lshlrev_b32 v50, 16, v133
    v_and_b32 v51, 0xffff0000, v133
    v_fmac_f32 v42, v60, v50
    v_fmac_f32 v43, v60, v51
    v_lshlrev_b32 v50, 16, v134
    v_and_b32 v51, 0xffff0000, v134
    v_fmac_f32 v44, v60, v50
    v_fmac_f32 v45, v60, v51
    v_lshlrev_b32 v50, 16, v135
    v_and_b32 v51, 0xffff0000, v135
    v_fmac_f32 v46, v60, v50
    v_fmac_f32 v47, v60, v51
    v_lshlrev_b32 v50, 16, v136
    v_and_b32 v51, 0xffff0000, v136
    v_fmac_f32 v40, v61, v50
    v_fmac_f32 v41, v61, v51
    v_lshlrev_b32 v50, 16, v137
    v_and_b32 v51, 0xffff0000, v137
    v_fmac_f32 v42, v61, v50
    v_fmac_f32 v43, v61, v51
    v_lshlrev_b32 v50, 16, v138
    v_and_b32 v51, 0xffff0000, v138
    v_fmac_f32 v44, v61, v50
    v_fmac_f32 v45, v61, v51
    v_lshlrev_b32 v50, 16, v139
    v_and_b32 v51, 0xffff0000, v139
    v_fmac_f32 v46, v61, v50
    v_fmac_f32 v47, v61, v51
    v_lshlrev_b32 v50, 16, v140
    v_and_b32 v51, 0xffff0000, v140
    v_fmac_f32 v40, v62, v50
    v_fmac_f32 v41, v62, v51
    v_lshlrev_b32 v50, 16, v141
    v_and_b32 v51, 0xffff0000, v141
    v_fmac_f32 v42, v62, v50
    v_fmac_f32 v43, v62, v51
    v_lshlrev_b32 v50, 16, v142
    v_and_b32 v51, 0xffff0000, v142
    v_fmac_f32 v44, v62, v50
    v_fmac_f32 v45, v62, v51
    v_lshlrev_b32 v50, 16, v143
    v_and_b32 v51, 0xffff0000, v143
    v_fmac_f32 v46, v62, v50
    v_fmac_f32 v47, v62, v51
    v_lshlrev_b32 v50, 16, v144
    v_and_b32 v51, 0xffff0000, v144
    v_fmac_f32 v40, v63, v50
    v_fmac_f32 v41, v63, v51
    v_lshlrev_b32 v50, 16, v145
    v_and_b32 v51, 0xffff0000, v145
    v_fmac_f32 v42, v63, v50
    v_fmac_f32 v43, v63, v51
    v_lshlrev_b32 v50, 16, v146
    v_and_b32 v51, 0xffff0000, v146
    v_fmac_f32 v44, v63, v50
    v_fmac_f32 v45, v63, v51
    v_lshlrev_b32 v50, 16, v147
    v_and_b32 v51, 0xffff0000, v147
    v_fmac_f32 v46, v63, v50
    v_fmac_f32 v47, v63, v51
    v_mul_u32_u24 v13, 2304, v1
    v_lshl_add_u32 v13, v2, 5, v13
    ds_write_b128 v13, v[40:43] offset:4864
    ds_write_b128 v13, v[44:47] offset:4880
    s_waitcnt lgkmcnt(0)
    s_barrier
    v_lshlrev_b32 v14, 2, v0

    ds_read_b32 v40, v14 offset:4864
    ds_read_b32 v41, v14 offset:7168
    ds_read_b32 v42, v14 offset:9472
    ds_read_b32 v43, v14 offset:11776
    ds_read_b32 v44, v14 offset:14080
    ds_read_b32 v45, v14 offset:16384
    ds_read_b32 v46, v14 offset:18688
    ds_read_b32 v47, v14 offset:20992
    s_waitcnt lgkmcnt(0)
    v_add_f32 v40, v40, v41
    v_add_f32 v40, v40, v42
    v_add_f32 v40, v40, v43
    v_add_f32 v40, v40, v44
    v_add_f32 v40, v40, v45
    v_add_f32 v40, v40, v46
    v_add_f32 v40, v40, v47
    s_mul_i32 s21, s20, 2304
    s_add_u32 s21, s21, 368640
    v_add_u32 v14, s21, v14
    global_atomic_add_f32 v14, v40, s[8:9]

    s_waitcnt vmcnt(0)
    s_waitcnt vmcnt(0)
    s_barrier
    v_cmp_eq_u32 vcc, 0, v0
    s_and_saveexec_b64 s[16:17], vcc
    v_mov_b32 v40, 1
    v_mov_b32 v41, 405504
    global_atomic_add v42, v41, v40, s[8:9] sc0
    s_waitcnt vmcnt(0)
    v_mov_b32 v41, 0
    ds_write_b32 v41, v42
    s_mov_b64 exec, s[16:17]
    s_waitcnt lgkmcnt(0)
    s_barrier
    v_mov_b32 v41, 0
    ds_read_b32 v42, v41
    s_waitcnt lgkmcnt(0)
    v_readfirstlane_b32 s33, v42
    s_cmp_lg_u32 s33, 143
    s_cbranch_scc1 K4_END
    v_lshlrev_b32 v14, 2, v0
    v_add_u32 v15, 368640, v14

    global_load_dword v61, v15, s[8:9] sc0 sc1
    v_add_u32 v15, 2304, v15
    global_load_dword v62, v15, s[8:9] sc0 sc1
    v_add_u32 v15, 2304, v15
    global_load_dword v63, v15, s[8:9] sc0 sc1
    v_add_u32 v15, 2304, v15
    global_load_dword v64, v15, s[8:9] sc0 sc1
    v_add_u32 v15, 2304, v15
    global_load_dword v65, v15, s[8:9] sc0 sc1
    v_add_u32 v15, 2304, v15
    global_load_dword v66, v15, s[8:9] sc0 sc1
    v_add_u32 v15, 2304, v15
    global_load_dword v67, v15, s[8:9] sc0 sc1
    v_add_u32 v15, 2304, v15
    global_load_dword v68, v15, s[8:9] sc0 sc1
    v_add_u32 v15, 2304, v15
    global_load_dword v69, v15, s[8:9] sc0 sc1
    v_add_u32 v15, 2304, v15
    global_load_dword v70, v15, s[8:9] sc0 sc1
    v_add_u32 v15, 2304, v15
    global_load_dword v71, v15, s[8:9] sc0 sc1
    v_add_u32 v15, 2304, v15
    global_load_dword v72, v15, s[8:9] sc0 sc1
    v_add_u32 v15, 2304, v15
    global_load_dword v73, v15, s[8:9] sc0 sc1
    v_add_u32 v15, 2304, v15
    global_load_dword v74, v15, s[8:9] sc0 sc1
    v_add_u32 v15, 2304, v15
    global_load_dword v75, v15, s[8:9] sc0 sc1
    v_add_u32 v15, 2304, v15
    global_load_dword v76, v15, s[8:9] sc0 sc1
    v_lshlrev_b32 v16, 1, v0
    global_load_ushort v77, v16, s[34:35]
    s_waitcnt vmcnt(0)
    v_add_f32 v61, v61, v62
    v_add_f32 v61, v61, v63
    v_add_f32 v61, v61, v64
    v_add_f32 v61, v61, v65
    v_add_f32 v61, v61, v66
    v_add_f32 v61, v61, v67
    v_add_f32 v61, v61, v68
    v_add_f32 v61, v61, v69
    v_add_f32 v61, v61, v70
    v_add_f32 v61, v61, v71
    v_add_f32 v61, v61, v72
    v_add_f32 v61, v61, v73
    v_add_f32 v61, v61, v74
    v_add_f32 v61, v61, v75
    v_add_f32 v61, v61, v76
    v_cvt_pk_bf16_f32 v61, v61, v61
    v_lshlrev_b32 v61, 16, v61
    v_lshlrev_b32 v77, 16, v77
    v_add_f32 v61, v61, v77
    v_cvt_pk_bf16_f32 v61, v61, v61
    v_lshlrev_b32 v61, 16, v61
    v_add_f32 v61, v61, v59
    v_cvt_pk_bf16_f32 v61, v61, v61
    global_store_short v16, v61, s[36:37]
K4_END:
    s_endpgm
.section .rodata,"a"
.p2align 6
.amdhsa_kernel k1_qproj_kernel
  .amdhsa_next_free_vgpr 96
  .amdhsa_next_free_sgpr 102
  .amdhsa_accum_offset 96
  .amdhsa_group_segment_fixed_size 0
  .amdhsa_kernarg_size 104
  .amdhsa_user_sgpr_count 2
  .amdhsa_user_sgpr_kernarg_segment_ptr 1
  .amdhsa_system_sgpr_workgroup_id_x 1
.end_amdhsa_kernel

.p2align 6
.amdhsa_kernel k2_attn_kernel
  .amdhsa_next_free_vgpr 160
  .amdhsa_next_free_sgpr 102
  .amdhsa_accum_offset 160
  .amdhsa_group_segment_fixed_size 0
  .amdhsa_kernarg_size 104
  .amdhsa_user_sgpr_count 2
  .amdhsa_user_sgpr_kernarg_segment_ptr 1
  .amdhsa_system_sgpr_workgroup_id_x 1
.end_amdhsa_kernel

.p2align 6
.amdhsa_kernel k3_wo_kernel
  .amdhsa_next_free_vgpr 96
  .amdhsa_next_free_sgpr 102
  .amdhsa_accum_offset 96
  .amdhsa_group_segment_fixed_size 0
  .amdhsa_kernarg_size 104
  .amdhsa_user_sgpr_count 2
  .amdhsa_user_sgpr_kernarg_segment_ptr 1
  .amdhsa_system_sgpr_workgroup_id_x 1
.end_amdhsa_kernel

.p2align 6
.amdhsa_kernel k4_mlp_kernel
  .amdhsa_next_free_vgpr 168
  .amdhsa_next_free_sgpr 102
  .amdhsa_accum_offset 168
  .amdhsa_group_segment_fixed_size 0
  .amdhsa_kernarg_size 104
  .amdhsa_user_sgpr_count 2
  .amdhsa_user_sgpr_kernarg_segment_ptr 1
  .amdhsa_system_sgpr_workgroup_id_x 1
.end_amdhsa_kernel
```
